```python
import torch

def _softmax(x, axis=-1):
    return torch.softmax(x, dim=axis)

def _gelu(x):
    return torch.nn.functional.gelu(x, approximate='tanh')

def _silu(x):
    return torch.nn.functional.silu(x)

def _sigmoid(x):
    return torch.sigmoid(x)

def _layernorm(x, axis=-1, eps=1e-05):
    m = x.mean(dim=axis, keepdim=True)
    v = x.var(dim=axis, keepdim=True, unbiased=False)
    return (x - m) / torch.sqrt(v + eps)

def _scatter_add(tgt, idx, src, axis=0):
    return tgt.clone().index_add_(axis, idx, src)

def _segment_sum(src, seg, n):
    out = torch.zeros((n,) + src.shape[1:], dtype=src.dtype)
    return out.index_add_(0, seg, src)

def _pad(x, pw):
    flat = tuple((v for pair in reversed(pw) for v in pair))
    return torch.nn.functional.pad(x, flat)
kernel_name = 'adaLN_cond__sliding_block_cached__swiglu_ffn__decode'

def setup_inputs():

    _w = lambda a: (lambda t: t.to(torch.bfloat16) if t.is_floating_point() else t)(torch.as_tensor(a))

    def _A_setup():
        B, Sq, D = (8, 1, 512)
        Hq, Hkv, Sk, Dh = (32, 8, 8192, 128)
        assert Hq % Hkv == 0, (Hq, Hkv)
        return {'x': _w((lambda *s: torch.randn(*s, dtype=torch.bfloat16) * 0.05)(B, Sq, D)), 'k_cache': _w((lambda *s: torch.randn(*s, dtype=torch.bfloat16) * 3.2)(B, Hkv, Sk, Dh)), 'v_cache': _w((lambda *s: torch.randn(*s, dtype=torch.bfloat16) * 0.4)(B, Hkv, Sk, Dh)), 'wq': _w((lambda *s: torch.randn(*s, dtype=torch.bfloat16) * 3.2)(D, Hq * Dh) * D ** (-0.5)), 'wo': _w((lambda *s: torch.randn(*s, dtype=torch.bfloat16) * 0.4)(Hq * Dh, D) * (Hq * Dh) ** (-0.5))}
    _A_in = _A_setup()

    def _B_setup():
        B, S, D, F = (8, 1, 512, 1792)
        return {'x': _w((lambda *s: torch.randn(*s, dtype=torch.bfloat16) * 0.05)(B, S, D)), 'w_gate': _w((lambda *s: torch.randn(*s, dtype=torch.bfloat16) * 0.05)(D, F)), 'w_up': _w((lambda *s: torch.randn(*s, dtype=torch.bfloat16) * 0.05)(D, F)), 'w_down': _w((lambda *s: torch.randn(*s, dtype=torch.bfloat16) * 0.05)(F, D))}
    _B_in = _B_setup()
    return {'A_x': _A_in['x'], 'A_k_cache': _A_in['k_cache'], 'A_v_cache': _A_in['v_cache'], 'A_wq': _A_in['wq'], 'A_wo': _A_in['wo'], 'B_x': _B_in['x'], 'B_w_gate': _B_in['w_gate'], 'B_w_up': _B_in['w_up'], 'B_w_down': _B_in['w_down'], 'c': _w((lambda *s: torch.randn(*s, dtype=torch.bfloat16) * 0.1)(8, 512) * 8.0), 'w_mod': _w((lambda *s: torch.randn(*s, dtype=torch.bfloat16) * 0.1)(512, 6 * 512) * 512 ** (-0.5) * 8.0)}

def reference(A_x, A_k_cache, A_v_cache, A_wq, A_wo, B_x, B_w_gate, B_w_up, B_w_down, c, w_mod):

    def _A_ref(x, k_cache, v_cache, wq, wo):
        B, Sq, D = x.shape
        Hq, Dh = (32, 128)
        Hkv, Sk = (k_cache.shape[1], k_cache.shape[2])
        W = min(4096, max(256, Sk // 4))
        rep = Hq // Hkv
        q = (lambda x, *d: x.permute(*d))((x @ wq).reshape(B, Sq, Hq, Dh), 0, 2, 1, 3)
        k = (lambda x, n, axis: torch.repeat_interleave(x, n, dim=axis))(k_cache[:, :, Sk - W:, :], rep, axis=1)
        v = (lambda x, n, axis: torch.repeat_interleave(x, n, dim=axis))(v_cache[:, :, Sk - W:, :], rep, axis=1)
        scores = torch.einsum('bhqd,bhkd->bhqk', q, k) * Dh ** (-0.5)
        p = _softmax(scores, axis=-1)
        o = torch.einsum('bhqk,bhkd->bhqd', p, v)
        return (lambda x, *d: x.permute(*d))(o, 0, 2, 1, 3).reshape(B, Sq, Hq * Dh) @ wo

    def _B_ref(x, w_gate, w_up, w_down):
        g = _silu(x @ w_gate)
        u = x @ w_up
        return g * u @ w_down
    x = A_x
    mod = (_silu(c) @ w_mod).reshape(c.shape[0], 6, 1, -1)
    sa, ca, ga, sb, cb, gb = (mod[:, 0].clone(), mod[:, 1].clone(), mod[:, 2].clone(), mod[:, 3].clone(), mod[:, 4].clone(), mod[:, 5].clone())
    h = _layernorm(x, axis=-1) * (1 + ca) + sa
    x = x + ga * _A_ref(h, A_k_cache, A_v_cache, A_wq, A_wo)
    h = _layernorm(x, axis=-1) * (1 + cb) + sb
    x = x + gb * _B_ref(h, B_w_gate, B_w_up, B_w_down)
    return x
```

```asm
; @launch grid=(256,1,1) block=(512,1,1) lds=148736
.amdgcn_target "amdgcn-amd-amdhsa--gfx950"
.text
.globl adaLN_cond__sliding_block_cached__swiglu_ffn__decode_kernel
.p2align 8
.type adaLN_cond__sliding_block_cached__swiglu_ffn__decode_kernel,@function
adaLN_cond__sliding_block_cached__swiglu_ffn__decode_kernel:
    s_cmp_ge_u32 s2, 256
    s_cbranch_scc1 L_end
    s_load_dwordx16 s[16:31], s[0:1], 0
    s_load_dwordx8 s[32:39], s[0:1], 64
    s_load_dwordx4 s[40:43], s[0:1], 96
    v_lshrrev_b32 v2, 6, v0
    v_and_b32 v1, 63, v0
    v_readfirstlane_b32 s3, v2
    s_and_b32 s66, s2, 7
    s_lshr_b32 s67, s2, 3
    s_mov_b32 s64, 0x05040100
    s_mov_b32 s65, 0x07060302
    s_getreg_b32 s99, hwreg(HW_REG_XCC_ID, 0, 4)
    s_mov_b32 s98, 0
    v_lshrrev_b32 v2, 4, v1
    v_bfe_u32 v3, v1, 3, 1
    v_and_b32 v4, 7, v1
    v_lshlrev_b32 v7, 4, v1
    v_lshlrev_b32 v5, 5, v3
    v_lshl_add_u32 v5, v2, 3, v5
    s_waitcnt lgkmcnt(0)
    s_mov_b32 s44, s42
    s_and_b32 s45, s43, 0xffff
    s_mov_b32 s46, 8388608
    s_mov_b32 s47, 0x20000
    s_lshr_b32 s14, s67, 2
    s_and_b32 s15, s67, 3
    s_cmp_eq_u32 s15, 0
    s_cbranch_scc1 L_Q
    s_cmp_lt_u32 s67, 24
    s_cselect_b32 s68, s15, 0
    s_cmp_eq_u32 s68, 1
    s_cbranch_scc1 L_MA
    s_mov_b32 s60, s18
    s_and_b32 s61, s19, 0xffff
    s_mov_b32 s62, 134217728
    s_mov_b32 s63, 0x20000
    s_mov_b32 s56, s20
    s_and_b32 s57, s21, 0xffff
    s_mov_b32 s58, 134217728
    s_mov_b32 s59, 0x20000
    s_lshl_b32 s8, s14, 3
    s_add_u32 s8, s8, s66
    s_lshl_b32 s4, s8, 21
    s_add_u32 s4, s4, 1572864
    s_lshl_b32 s7, s3, 12
    s_add_u32 s4, s4, s7
    s_lshl_b32 s7, s15, 17
    s_add_u32 s4, s4, s7
    s_lshl_b32 s6, s3, 14
    v_and_b32 v27, 15, v1
    v_add_u32 v12, 0, v2
    v_xor_b32 v13, v12, v27
    v_lshlrev_b32 v13, 4, v13
    v_lshl_add_u32 v18, v12, 8, v13
    v_add_u32 v12, 4, v2
    v_xor_b32 v13, v12, v27
    v_lshlrev_b32 v13, 4, v13
    v_lshl_add_u32 v19, v12, 8, v13
    v_add_u32 v12, 8, v2
    v_xor_b32 v13, v12, v27
    v_lshlrev_b32 v13, 4, v13
    v_lshl_add_u32 v20, v12, 8, v13
    v_add_u32 v12, 12, v2
    v_xor_b32 v13, v12, v27
    v_lshlrev_b32 v13, 4, v13
    v_lshl_add_u32 v21, v12, 8, v13
    s_cmp_lt_u32 s67, 8
    s_cselect_b32 s5, 2, 0
    s_cmp_eq_u32 s15, 2
    s_cselect_b32 s5, 2, s5
    s_add_u32 s7, s4, 0
    s_add_u32 m0, s6, 0
    s_nop 0
    buffer_load_dwordx4 v18, s[60:63], s7 offen nt lds
    buffer_load_dword v6, off, s[44:47], 0 offset:0 sc1
    v_add_u32 v12, 0, v2
    v_xor_b32 v12, v12, v27
    v_lshlrev_b32 v12, 4, v12
    v_lshl_add_u32 v12, v27, 8, v12
    v_add_u32 v22, s6, v12
    v_add_u32 v12, 4, v2
    v_xor_b32 v12, v12, v27
    v_lshlrev_b32 v12, 4, v12
    v_lshl_add_u32 v12, v27, 8, v12
    v_add_u32 v23, s6, v12
    v_add_u32 v12, 8, v2
    v_xor_b32 v12, v12, v27
    v_lshlrev_b32 v12, 4, v12
    v_lshl_add_u32 v12, v27, 8, v12
    v_add_u32 v24, s6, v12
    v_add_u32 v12, 12, v2
    v_xor_b32 v12, v12, v27
    v_lshlrev_b32 v12, 4, v12
    v_lshl_add_u32 v12, v27, 8, v12
    v_add_u32 v25, s6, v12
    v_lshlrev_b32 v28, 10, v2
    v_lshl_add_u32 v28, v27, 4, v28
    v_and_b32 v12, 3, v1
    v_lshlrev_b32 v13, 8, v12
    v_lshl_add_u32 v26, v2, 4, v13
    v_add_u32 v26, 147456, v26
    v_lshlrev_b32 v33, 5, v12
    v_add_u32 v33, 148480, v33
    s_lshl_b32 s68, s3, 11
    s_add_u32 s68, s68, 131072
    v_add_u32 v13, 0, v2
    v_xor_b32 v13, v13, v4
    v_lshl_add_u32 v13, v27, 3, v13
    v_lshlrev_b32 v13, 4, v13
    v_add_u32 v29, s68, v13
    v_add_u32 v13, 4, v2
    v_xor_b32 v13, v13, v4
    v_lshl_add_u32 v13, v27, 3, v13
    v_lshlrev_b32 v13, 4, v13
    v_add_u32 v30, s68, v13
    s_and_b32 s68, s3, 3
    s_lshl_b32 s68, s68, 2
    s_add_u32 s68, s68, 131072
    v_bfe_u32 v14, v1, 2, 3
    v_lshl_add_u32 v13, v1, 1, 0
    v_xor_b32 v13, v13, v14
    v_lshlrev_b32 v13, 4, v13
    v_add_u32 v31, s68, v13
    v_lshl_add_u32 v13, v1, 1, 1
    v_xor_b32 v13, v13, v14
    v_lshlrev_b32 v13, 4, v13
    v_add_u32 v32, s68, v13
    v_lshlrev_b32 v27, 3, v1
    v_add_u32 v27, 147456, v27
    s_cmp_lg_u32 s5, 0
    s_cbranch_scc1 Lf_1
    s_waitcnt vmcnt(1)
Lf_1:
    s_waitcnt vmcnt(3)
    s_add_u32 m0, s6, 1024
    s_nop 0
    buffer_load_dwordx4 v19, s[60:63], s7 offen nt lds
    s_cmp_lg_u32 s5, 0
    s_cbranch_scc1 Lf_2
    s_waitcnt vmcnt(1)
Lf_2:
    s_waitcnt vmcnt(3)
    s_add_u32 m0, s6, 2048
    s_nop 0
    buffer_load_dwordx4 v20, s[60:63], s7 offen nt lds
    s_cmp_lg_u32 s5, 0
    s_cbranch_scc1 Lf_3
    s_waitcnt vmcnt(1)
Lf_3:
    s_waitcnt vmcnt(3)
    s_add_u32 m0, s6, 3072
    s_nop 0
    buffer_load_dwordx4 v21, s[60:63], s7 offen nt lds
    s_cmp_lg_u32 s5, 0
    s_cbranch_scc1 Lf_4
    s_waitcnt vmcnt(1)
Lf_4:
    s_waitcnt vmcnt(3)
    s_add_u32 s7, s4, 32768
    s_add_u32 m0, s6, 4096
    s_nop 0
    buffer_load_dwordx4 v18, s[60:63], s7 offen nt lds
    s_cmp_lg_u32 s5, 0
    s_cbranch_scc1 Lf_5
    s_waitcnt vmcnt(1)
Lf_5:
    s_waitcnt vmcnt(3)
    s_add_u32 m0, s6, 5120
    s_nop 0
    buffer_load_dwordx4 v19, s[60:63], s7 offen nt lds
    s_cmp_lg_u32 s5, 0
    s_cbranch_scc1 Lf_6
    s_waitcnt vmcnt(1)
Lf_6:
    s_waitcnt vmcnt(3)
    s_add_u32 m0, s6, 6144
    s_nop 0
    buffer_load_dwordx4 v20, s[60:63], s7 offen nt lds
    v_readfirstlane_b32 s78, v6
    s_add_u32 s78, s78, 0x9e3779b9
    s_cmp_lg_u32 s3, 0
    s_cbranch_scc1 Lxid_7
    v_mov_b32 v36, s99
    v_mov_b32 v37, s78
    v_mov_b32 v38, s99
    v_mov_b32 v39, s78
    s_lshl_b32 s68, s66, 9
    s_lshr_b32 s98, s2, 3
    s_lshl_b32 s98, s98, 4
    s_add_u32 s68, s68, s98
    s_add_u32 s68, s68, 4096
    s_mov_b64 exec, 1
    buffer_store_dwordx4 v[36:39], off, s[44:47], s68 sc1
    s_mov_b64 exec, -1
Lxid_7:
    s_cmp_lg_u32 s5, 0
    s_cbranch_scc1 Lf_8
    s_waitcnt vmcnt(1)
Lf_8:
    s_waitcnt vmcnt(3)
    s_add_u32 m0, s6, 7168
    s_nop 0
    buffer_load_dwordx4 v21, s[60:63], s7 offen nt lds
    s_cmp_lg_u32 s5, 0
    s_cbranch_scc1 Lf_9
    s_waitcnt vmcnt(1)
Lf_9:
    s_waitcnt vmcnt(3)
    s_add_u32 s7, s4, 65536
    s_add_u32 m0, s6, 8192
    s_nop 0
    buffer_load_dwordx4 v18, s[60:63], s7 offen nt lds
    s_cmp_lg_u32 s5, 0
    s_cbranch_scc1 Lf_10
    s_waitcnt vmcnt(1)
Lf_10:
    s_waitcnt vmcnt(3)
    s_add_u32 m0, s6, 9216
    s_nop 0
    buffer_load_dwordx4 v19, s[60:63], s7 offen nt lds
    s_cmp_lg_u32 s5, 0
    s_cbranch_scc1 Lf_11
    s_waitcnt vmcnt(1)
Lf_11:
    s_waitcnt vmcnt(3)
    s_add_u32 m0, s6, 10240
    s_nop 0
    buffer_load_dwordx4 v20, s[60:63], s7 offen nt lds
    s_cmp_lg_u32 s5, 0
    s_cbranch_scc1 Lf_12
    s_waitcnt vmcnt(1)
Lf_12:
    s_waitcnt vmcnt(3)
    s_add_u32 m0, s6, 11264
    s_nop 0
    buffer_load_dwordx4 v21, s[60:63], s7 offen nt lds
    s_cmp_lg_u32 s5, 0
    s_cbranch_scc1 Lf_13
    s_waitcnt vmcnt(1)
Lf_13:
    s_waitcnt vmcnt(3)
    s_add_u32 s7, s4, 98304
    s_add_u32 m0, s6, 12288
    s_nop 0
    buffer_load_dwordx4 v18, s[60:63], s7 offen nt lds
    s_cmp_lg_u32 s5, 0
    s_cbranch_scc1 Lf_14
    s_waitcnt vmcnt(1)
Lf_14:
    s_waitcnt vmcnt(3)
    s_add_u32 m0, s6, 13312
    s_nop 0
    buffer_load_dwordx4 v19, s[60:63], s7 offen nt lds
    s_cmp_lg_u32 s5, 0
    s_cbranch_scc1 Lf_15
    s_waitcnt vmcnt(1)
Lf_15:
    s_waitcnt vmcnt(3)
    s_add_u32 m0, s6, 14336
    s_nop 0
    buffer_load_dwordx4 v20, s[60:63], s7 offen nt lds
    s_cmp_lg_u32 s5, 0
    s_cbranch_scc1 Lf_16
    s_waitcnt vmcnt(1)
Lf_16:
    s_waitcnt vmcnt(3)
    s_add_u32 m0, s6, 15360
    s_nop 0
    buffer_load_dwordx4 v21, s[60:63], s7 offen nt lds
    s_branch L_VS
L_MA:
    s_mul_i32 s69, s14, 3
    s_add_u32 s69, s69, s66
    s_and_b32 s69, s69, 7
    s_lshl_b32 s68, s14, 3
    s_add_u32 s69, s69, s68
    s_mov_b32 s48, s36
    s_and_b32 s49, s37, 0xffff
    s_mov_b32 s50, 3145728
    s_mov_b32 s51, 0x20000
    s_mov_b32 s52, s34
    s_and_b32 s53, s35, 0xffff
    s_mov_b32 s54, 8192
    s_mov_b32 s55, 0x20000
    v_mul_u32_u24 v125, 6144, v5
    v_lshl_add_u32 v125, v4, 4, v125
    s_mul_i32 s70, s3, 393216
    s_lshl_b32 s68, s69, 7
    s_add_u32 s70, s70, s68
    v_lshlrev_b32 v124, 10, v4
    v_lshl_add_u32 v124, v5, 1, v124
    s_lshl_b32 s68, s3, 7
    buffer_load_dwordx4 v[104:107], v124, s[52:55], s68 offen
    buffer_load_dword v6, off, s[44:47], 0 offset:0 sc1
    buffer_load_dwordx4 v[40:43], v125, s[48:51], s70 offen offset:0 nt
    s_add_u32 s70, s70, 6144
    buffer_load_dwordx4 v[44:47], v125, s[48:51], s70 offen offset:0 nt
    s_add_u32 s70, s70, 6144
    buffer_load_dwordx4 v[48:51], v125, s[48:51], s70 offen offset:0 nt
    s_add_u32 s70, s70, 6144
    buffer_load_dwordx4 v[52:55], v125, s[48:51], s70 offen offset:0 nt
    s_add_u32 s70, s70, 6144
    buffer_load_dwordx4 v[56:59], v125, s[48:51], s70 offen offset:0 nt
    s_add_u32 s70, s70, 6144
    buffer_load_dwordx4 v[60:63], v125, s[48:51], s70 offen offset:0 nt
    s_add_u32 s70, s70, 6144
    buffer_load_dwordx4 v[64:67], v125, s[48:51], s70 offen offset:0 nt
    s_add_u32 s70, s70, 6144
    buffer_load_dwordx4 v[68:71], v125, s[48:51], s70 offen offset:0 nt
    s_cmp_ge_u32 s69, 16
    s_cbranch_scc1 Lnc_17
    v_mov_b32 v136, -1
    v_mov_b32 v137, -1
    v_mov_b32 v138, -1
    v_mov_b32 v139, -1
    s_lshl_b32 s68, s69, 3
    s_add_u32 s68, s68, s3
    s_mul_i32 s68, s68, 1408
    s_add_u32 s68, s68, 65536
    buffer_store_dwordx4 v[136:139], v7, s[44:47], s68 offen sc1
    s_mov_b64 exec, 0xffffff
    buffer_store_dwordx4 v[136:139], v7, s[44:47], s68 offen offset:1024 sc1
    s_mov_b64 exec, -1
Lnc_17:
    s_mov_b32 s60, s18
    s_and_b32 s61, s19, 0xffff
    s_mov_b32 s62, 134217728
    s_mov_b32 s63, 0x20000
    s_mov_b32 s56, s20
    s_and_b32 s57, s21, 0xffff
    s_mov_b32 s58, 134217728
    s_mov_b32 s59, 0x20000
    s_lshl_b32 s8, s14, 3
    s_add_u32 s8, s8, s66
    s_lshl_b32 s4, s8, 21
    s_add_u32 s4, s4, 1572864
    s_lshl_b32 s7, s3, 12
    s_add_u32 s4, s4, s7
    s_lshl_b32 s7, s15, 17
    s_add_u32 s4, s4, s7
    s_lshl_b32 s6, s3, 14
    v_and_b32 v27, 15, v1
    v_add_u32 v12, 0, v2
    v_xor_b32 v13, v12, v27
    v_lshlrev_b32 v13, 4, v13
    v_lshl_add_u32 v18, v12, 8, v13
    v_add_u32 v12, 4, v2
    v_xor_b32 v13, v12, v27
    v_lshlrev_b32 v13, 4, v13
    v_lshl_add_u32 v19, v12, 8, v13
    v_add_u32 v12, 8, v2
    v_xor_b32 v13, v12, v27
    v_lshlrev_b32 v13, 4, v13
    v_lshl_add_u32 v20, v12, 8, v13
    v_add_u32 v12, 12, v2
    v_xor_b32 v13, v12, v27
    v_lshlrev_b32 v13, 4, v13
    v_lshl_add_u32 v21, v12, 8, v13
    v_and_b32 v10, 1, v2
    v_lshrrev_b32 v13, 5, v1
    s_lshl_b32 s68, s3, 14
    s_add_u32 s68, s68, 12288
    v_add_u32 v11, 0, v10
    v_xor_b32 v12, v11, v4
    v_lshl_add_u32 v11, v11, 3, v12
    v_lshlrev_b32 v11, 4, v11
    v_lshl_add_u32 v11, v13, 11, v11
    v_add_u32 v126, s68, v11
    v_add_u32 v11, 2, v10
    v_xor_b32 v12, v11, v4
    v_lshl_add_u32 v11, v11, 3, v12
    v_lshlrev_b32 v11, 4, v11
    v_lshl_add_u32 v11, v13, 11, v11
    v_add_u32 v127, s68, v11
    v_add_u32 v11, 4, v10
    v_xor_b32 v12, v11, v4
    v_lshl_add_u32 v11, v11, 3, v12
    v_lshlrev_b32 v11, 4, v11
    v_lshl_add_u32 v11, v13, 11, v11
    v_add_u32 v128, s68, v11
    v_add_u32 v11, 6, v10
    v_xor_b32 v12, v11, v4
    v_lshl_add_u32 v11, v11, 3, v12
    v_lshlrev_b32 v11, 4, v11
    v_lshl_add_u32 v11, v13, 11, v11
    v_add_u32 v129, s68, v11
    v_lshrrev_b32 v10, 2, v1
    v_and_b32 v11, 7, v10
    v_xor_b32 v11, s3, v11
    v_lshl_add_u32 v10, v10, 3, v11
    v_and_b32 v11, 3, v1
    v_lshlrev_b32 v11, 2, v11
    v_lshl_add_u32 v130, v10, 4, v11
    v_add_u32 v130, 12288, v130
    v_add_u32 v132, 65536, v130
    v_lshrrev_b32 v131, 5, v1
    v_lshlrev_b32 v131, 10, v131
    v_lshl_add_u32 v131, v4, 4, v131
    s_lshl_b32 s71, s69, 11
    s_add_u32 s71, s71, 262144
    s_and_b32 s68, s3, 3
    s_lshl_b32 s68, s68, 8
    s_add_u32 s71, s71, s68
    s_lshr_b32 s68, s3, 2
    s_lshl_b32 s68, s68, 7
    s_add_u32 s71, s71, s68
    s_waitcnt vmcnt(8)
    v_readfirstlane_b32 s78, v6
    s_add_u32 s78, s78, 0x9e3779b9
    s_cmp_lg_u32 s3, 0
    s_cbranch_scc1 Lxid_18
    v_mov_b32 v72, s99
    v_mov_b32 v73, s78
    v_mov_b32 v74, s99
    v_mov_b32 v75, s78
    s_lshl_b32 s68, s66, 9
    s_lshr_b32 s98, s2, 3
    s_lshl_b32 s98, s98, 4
    s_add_u32 s68, s68, s98
    s_add_u32 s68, s68, 4096
    s_mov_b64 exec, 1
    buffer_store_dwordx4 v[72:75], off, s[44:47], s68 sc1
    s_mov_b64 exec, -1
Lxid_18:
    v_lshlrev_b32 v108, 16, v104
    v_and_b32 v109, 0xffff0000, v104
    v_lshlrev_b32 v110, 16, v105
    v_and_b32 v111, 0xffff0000, v105
    v_lshlrev_b32 v112, 16, v106
    v_and_b32 v113, 0xffff0000, v106
    v_lshlrev_b32 v114, 16, v107
    v_and_b32 v115, 0xffff0000, v107
    v_mul_f32 v116, 0xbfb8aa3b, v108
    v_mul_f32 v117, 0xbfb8aa3b, v109
    v_mul_f32 v118, 0xbfb8aa3b, v110
    v_mul_f32 v119, 0xbfb8aa3b, v111
    v_mul_f32 v120, 0xbfb8aa3b, v112
    v_mul_f32 v121, 0xbfb8aa3b, v113
    v_mul_f32 v122, 0xbfb8aa3b, v114
    v_mul_f32 v123, 0xbfb8aa3b, v115
    v_exp_f32 v116, v116
    v_exp_f32 v117, v117
    v_exp_f32 v118, v118
    v_exp_f32 v119, v119
    v_exp_f32 v120, v120
    v_exp_f32 v121, v121
    v_exp_f32 v122, v122
    v_exp_f32 v123, v123
    v_add_f32 v116, 1.0, v116
    v_add_f32 v117, 1.0, v117
    v_add_f32 v118, 1.0, v118
    v_add_f32 v119, 1.0, v119
    v_add_f32 v120, 1.0, v120
    v_add_f32 v121, 1.0, v121
    v_add_f32 v122, 1.0, v122
    v_add_f32 v123, 1.0, v123
    v_rcp_f32 v116, v116
    v_rcp_f32 v117, v117
    v_rcp_f32 v118, v118
    v_rcp_f32 v119, v119
    v_rcp_f32 v120, v120
    v_rcp_f32 v121, v121
    v_rcp_f32 v122, v122
    v_rcp_f32 v123, v123
    v_mul_f32 v108, v108, v116
    v_mul_f32 v109, v109, v117
    v_mul_f32 v110, v110, v118
    v_mul_f32 v111, v111, v119
    v_mul_f32 v112, v112, v120
    v_mul_f32 v113, v113, v121
    v_mul_f32 v114, v114, v122
    v_mul_f32 v115, v115, v123
    v_cvt_pk_bf16_f32 v104, v108, v109
    v_cvt_pk_bf16_f32 v105, v110, v111
    v_cvt_pk_bf16_f32 v106, v112, v113
    v_cvt_pk_bf16_f32 v107, v114, v115
    v_mov_b32 v137, s78
    v_mov_b32 v139, s78
    s_waitcnt vmcnt(6)
    v_perm_b32 v72, v44, v40, s64
    v_perm_b32 v76, v44, v40, s65
    v_perm_b32 v80, v45, v41, s64
    v_perm_b32 v84, v45, v41, s65
    v_perm_b32 v88, v46, v42, s64
    v_perm_b32 v92, v46, v42, s65
    v_perm_b32 v96, v47, v43, s64
    v_perm_b32 v100, v47, v43, s65
    s_waitcnt vmcnt(4)
    v_perm_b32 v73, v52, v48, s64
    v_perm_b32 v77, v52, v48, s65
    v_perm_b32 v81, v53, v49, s64
    v_perm_b32 v85, v53, v49, s65
    v_perm_b32 v89, v54, v50, s64
    v_perm_b32 v93, v54, v50, s65
    v_perm_b32 v97, v55, v51, s64
    v_perm_b32 v101, v55, v51, s65
    s_waitcnt vmcnt(2)
    v_perm_b32 v74, v60, v56, s64
    v_perm_b32 v78, v60, v56, s65
    v_perm_b32 v82, v61, v57, s64
    v_perm_b32 v86, v61, v57, s65
    v_perm_b32 v90, v62, v58, s64
    v_perm_b32 v94, v62, v58, s65
    v_perm_b32 v98, v63, v59, s64
    v_perm_b32 v102, v63, v59, s65
    s_waitcnt vmcnt(0)
    v_perm_b32 v75, v68, v64, s64
    v_perm_b32 v79, v68, v64, s65
    v_perm_b32 v83, v69, v65, s64
    v_perm_b32 v87, v69, v65, s65
    v_perm_b32 v91, v70, v66, s64
    v_perm_b32 v95, v70, v66, s65
    v_perm_b32 v99, v71, v67, s64
    v_perm_b32 v103, v71, v67, s65
    v_mfma_f32_16x16x32_bf16 v[40:43], v[104:107], v[72:75], 0
    v_mfma_f32_16x16x32_bf16 v[44:47], v[104:107], v[76:79], 0
    v_mfma_f32_16x16x32_bf16 v[48:51], v[104:107], v[80:83], 0
    v_mfma_f32_16x16x32_bf16 v[52:55], v[104:107], v[84:87], 0
    v_mfma_f32_16x16x32_bf16 v[56:59], v[104:107], v[88:91], 0
    v_mfma_f32_16x16x32_bf16 v[60:63], v[104:107], v[92:95], 0
    v_mfma_f32_16x16x32_bf16 v[64:67], v[104:107], v[96:99], 0
    v_mfma_f32_16x16x32_bf16 v[68:71], v[104:107], v[100:103], 0
    s_mov_b32 exec_lo, 0xff00ff
    s_mov_b32 exec_hi, 0xff00ff00
    ds_write_b128 v126, v[40:43] offset:0
    ds_write_b128 v127, v[44:47] offset:0
    ds_write_b128 v128, v[48:51] offset:0
    ds_write_b128 v129, v[52:55] offset:0
    ds_write_b128 v126, v[56:59] offset:1024
    ds_write_b128 v127, v[60:63] offset:1024
    ds_write_b128 v128, v[64:67] offset:1024
    ds_write_b128 v129, v[68:71] offset:1024
    s_mov_b64 exec, -1
    s_waitcnt lgkmcnt(0)
    s_barrier
    ds_read2st64_b32 v[72:73], v130 offset0:0 offset1:8
    ds_read2st64_b32 v[74:75], v130 offset0:64 offset1:72
    ds_read2st64_b32 v[76:77], v130 offset0:128 offset1:136
    ds_read2st64_b32 v[78:79], v130 offset0:192 offset1:200
    ds_read2st64_b32 v[80:81], v132 offset0:0 offset1:8
    ds_read2st64_b32 v[82:83], v132 offset0:64 offset1:72
    ds_read2st64_b32 v[84:85], v132 offset0:128 offset1:136
    ds_read2st64_b32 v[86:87], v132 offset0:192 offset1:200
    s_waitcnt lgkmcnt(6)
    v_pk_add_f32 v[72:73], v[72:73], v[74:75]
    s_waitcnt lgkmcnt(5)
    v_pk_add_f32 v[72:73], v[72:73], v[76:77]
    s_waitcnt lgkmcnt(4)
    v_pk_add_f32 v[72:73], v[72:73], v[78:79]
    s_waitcnt lgkmcnt(3)
    v_pk_add_f32 v[72:73], v[72:73], v[80:81]
    s_waitcnt lgkmcnt(2)
    v_pk_add_f32 v[72:73], v[72:73], v[82:83]
    s_waitcnt lgkmcnt(1)
    v_pk_add_f32 v[72:73], v[72:73], v[84:85]
    s_waitcnt lgkmcnt(0)
    v_pk_add_f32 v[72:73], v[72:73], v[86:87]
    v_add_f32 v108, v72, v73
    s_nop 1
    v_mov_b32_dpp v109, v108 row_ror:8 row_mask:0xf bank_mask:0xf
    v_cvt_pk_bf16_f32 v136, v108, v109
    v_cvt_pk_bf16_f32 v138, v108, v109
    s_nop 1
    v_permlane16_swap_b32 v136, v138
    s_mov_b32 exec_lo, 0xff
    s_mov_b32 exec_hi, 0xff
    buffer_store_dwordx4 v[136:139], v131, s[44:47], s71 offen sc1
    s_mov_b64 exec, -1
    v_add_u32 v12, 0, v2
    v_xor_b32 v12, v12, v27
    v_lshlrev_b32 v12, 4, v12
    v_lshl_add_u32 v12, v27, 8, v12
    v_add_u32 v22, s6, v12
    v_add_u32 v12, 4, v2
    v_xor_b32 v12, v12, v27
    v_lshlrev_b32 v12, 4, v12
    v_lshl_add_u32 v12, v27, 8, v12
    v_add_u32 v23, s6, v12
    v_add_u32 v12, 8, v2
    v_xor_b32 v12, v12, v27
    v_lshlrev_b32 v12, 4, v12
    v_lshl_add_u32 v12, v27, 8, v12
    v_add_u32 v24, s6, v12
    v_add_u32 v12, 12, v2
    v_xor_b32 v12, v12, v27
    v_lshlrev_b32 v12, 4, v12
    v_lshl_add_u32 v12, v27, 8, v12
    v_add_u32 v25, s6, v12
    v_lshlrev_b32 v28, 10, v2
    v_lshl_add_u32 v28, v27, 4, v28
    v_and_b32 v12, 3, v1
    v_lshlrev_b32 v13, 8, v12
    v_lshl_add_u32 v26, v2, 4, v13
    v_add_u32 v26, 147456, v26
    v_lshlrev_b32 v33, 5, v12
    v_add_u32 v33, 148480, v33
    s_lshl_b32 s68, s3, 11
    s_add_u32 s68, s68, 131072
    v_add_u32 v13, 0, v2
    v_xor_b32 v13, v13, v4
    v_lshl_add_u32 v13, v27, 3, v13
    v_lshlrev_b32 v13, 4, v13
    v_add_u32 v29, s68, v13
    v_add_u32 v13, 4, v2
    v_xor_b32 v13, v13, v4
    v_lshl_add_u32 v13, v27, 3, v13
    v_lshlrev_b32 v13, 4, v13
    v_add_u32 v30, s68, v13
    s_and_b32 s68, s3, 3
    s_lshl_b32 s68, s68, 2
    s_add_u32 s68, s68, 131072
    v_bfe_u32 v14, v1, 2, 3
    v_lshl_add_u32 v13, v1, 1, 0
    v_xor_b32 v13, v13, v14
    v_lshlrev_b32 v13, 4, v13
    v_add_u32 v31, s68, v13
    v_lshl_add_u32 v13, v1, 1, 1
    v_xor_b32 v13, v13, v14
    v_lshlrev_b32 v13, 4, v13
    v_add_u32 v32, s68, v13
    v_lshlrev_b32 v27, 3, v1
    v_add_u32 v27, 147456, v27
    s_waitcnt vmcnt(3)
    s_add_u32 s7, s4, 0
    s_add_u32 m0, s6, 0
    s_nop 0
    buffer_load_dwordx4 v18, s[60:63], s7 offen nt lds
    s_waitcnt vmcnt(3)
    s_add_u32 m0, s6, 1024
    s_nop 0
    buffer_load_dwordx4 v19, s[60:63], s7 offen nt lds
    s_waitcnt vmcnt(3)
    s_add_u32 m0, s6, 2048
    s_nop 0
    buffer_load_dwordx4 v20, s[60:63], s7 offen nt lds
    s_waitcnt vmcnt(3)
    s_add_u32 m0, s6, 3072
    s_nop 0
    buffer_load_dwordx4 v21, s[60:63], s7 offen nt lds
    s_waitcnt vmcnt(3)
    s_add_u32 s7, s4, 32768
    s_add_u32 m0, s6, 4096
    s_nop 0
    buffer_load_dwordx4 v18, s[60:63], s7 offen nt lds
    s_waitcnt vmcnt(3)
    s_add_u32 m0, s6, 5120
    s_nop 0
    buffer_load_dwordx4 v19, s[60:63], s7 offen nt lds
    s_waitcnt vmcnt(3)
    s_add_u32 m0, s6, 6144
    s_nop 0
    buffer_load_dwordx4 v20, s[60:63], s7 offen nt lds
    s_waitcnt vmcnt(3)
    s_add_u32 m0, s6, 7168
    s_nop 0
    buffer_load_dwordx4 v21, s[60:63], s7 offen nt lds
    s_waitcnt vmcnt(3)
    s_add_u32 s7, s4, 65536
    s_add_u32 m0, s6, 8192
    s_nop 0
    buffer_load_dwordx4 v18, s[60:63], s7 offen nt lds
    s_waitcnt vmcnt(3)
    s_add_u32 m0, s6, 9216
    s_nop 0
    buffer_load_dwordx4 v19, s[60:63], s7 offen nt lds
    s_waitcnt vmcnt(3)
    s_add_u32 m0, s6, 10240
    s_nop 0
    buffer_load_dwordx4 v20, s[60:63], s7 offen nt lds
    s_waitcnt vmcnt(3)
    s_add_u32 m0, s6, 11264
    s_nop 0
    buffer_load_dwordx4 v21, s[60:63], s7 offen nt lds
    s_barrier
    s_waitcnt vmcnt(3)
    s_add_u32 s7, s4, 98304
    s_add_u32 m0, s6, 12288
    s_nop 0
    buffer_load_dwordx4 v18, s[60:63], s7 offen nt lds
    s_waitcnt vmcnt(3)
    s_add_u32 m0, s6, 13312
    s_nop 0
    buffer_load_dwordx4 v19, s[60:63], s7 offen nt lds
    s_waitcnt vmcnt(3)
    s_add_u32 m0, s6, 14336
    s_nop 0
    buffer_load_dwordx4 v20, s[60:63], s7 offen nt lds
    s_waitcnt vmcnt(3)
    s_add_u32 m0, s6, 15360
    s_nop 0
    buffer_load_dwordx4 v21, s[60:63], s7 offen nt lds
    s_mov_b32 s5, 1
    s_branch L_VS
L_Q:
    s_mov_b32 s69, s14
    s_lshl_b32 s71, s66, 10
    s_lshl_b32 s68, s69, 7
    s_add_u32 s71, s71, s68
    s_mov_b32 s48, s22
    s_and_b32 s49, s23, 0xffff
    s_mov_b32 s50, 4194304
    s_mov_b32 s51, 0x20000
    s_mov_b32 s52, s16
    s_and_b32 s53, s17, 0xffff
    s_mov_b32 s54, 8192
    s_mov_b32 s55, 0x20000
    s_lshl_b32 s70, s3, 19
    s_add_u32 s70, s70, s71
    v_lshlrev_b32 v136, 10, v4
    v_lshl_add_u32 v136, v5, 1, v136
    s_lshl_b32 s68, s3, 7
    buffer_load_dwordx4 v[104:107], v136, s[52:55], s68 offen
    buffer_load_dword v6, off, s[44:47], 0 offset:0 sc1
    v_mul_u32_u24 v137, 65536, v2
    v_and_b32 v10, 15, v1
    v_lshl_add_u32 v137, v10, 3, v137
    buffer_load_dwordx2 v[40:41], v137, s[48:51], s70 offen offset:0 nt
    s_add_u32 s70, s70, 8192
    buffer_load_dwordx2 v[42:43], v137, s[48:51], s70 offen offset:0 nt
    s_add_u32 s70, s70, 8192
    buffer_load_dwordx2 v[44:45], v137, s[48:51], s70 offen offset:0 nt
    s_add_u32 s70, s70, 8192
    buffer_load_dwordx2 v[46:47], v137, s[48:51], s70 offen offset:0 nt
    s_add_u32 s70, s70, 8192
    buffer_load_dwordx2 v[48:49], v137, s[48:51], s70 offen offset:0 nt
    s_add_u32 s70, s70, 8192
    buffer_load_dwordx2 v[50:51], v137, s[48:51], s70 offen offset:0 nt
    s_add_u32 s70, s70, 8192
    buffer_load_dwordx2 v[52:53], v137, s[48:51], s70 offen offset:0 nt
    s_add_u32 s70, s70, 8192
    buffer_load_dwordx2 v[54:55], v137, s[48:51], s70 offen offset:0 nt
    s_add_u32 s70, s70, 204800
    buffer_load_dwordx2 v[56:57], v137, s[48:51], s70 offen offset:0 nt
    s_add_u32 s70, s70, 8192
    buffer_load_dwordx2 v[58:59], v137, s[48:51], s70 offen offset:0 nt
    s_add_u32 s70, s70, 8192
    buffer_load_dwordx2 v[60:61], v137, s[48:51], s70 offen offset:0 nt
    s_add_u32 s70, s70, 8192
    buffer_load_dwordx2 v[62:63], v137, s[48:51], s70 offen offset:0 nt
    s_add_u32 s70, s70, 8192
    buffer_load_dwordx2 v[64:65], v137, s[48:51], s70 offen offset:0 nt
    s_add_u32 s70, s70, 8192
    buffer_load_dwordx2 v[66:67], v137, s[48:51], s70 offen offset:0 nt
    s_add_u32 s70, s70, 8192
    buffer_load_dwordx2 v[68:69], v137, s[48:51], s70 offen offset:0 nt
    s_add_u32 s70, s70, 8192
    buffer_load_dwordx2 v[70:71], v137, s[48:51], s70 offen offset:0 nt
    s_mov_b32 s60, s18
    s_and_b32 s61, s19, 0xffff
    s_mov_b32 s62, 134217728
    s_mov_b32 s63, 0x20000
    s_mov_b32 s56, s20
    s_and_b32 s57, s21, 0xffff
    s_mov_b32 s58, 134217728
    s_mov_b32 s59, 0x20000
    s_lshl_b32 s8, s14, 3
    s_add_u32 s8, s8, s66
    s_lshl_b32 s4, s8, 21
    s_add_u32 s4, s4, 1572864
    s_lshl_b32 s7, s3, 12
    s_add_u32 s4, s4, s7
    s_lshl_b32 s7, s15, 17
    s_add_u32 s4, s4, s7
    s_lshl_b32 s6, s3, 14
    v_and_b32 v27, 15, v1
    v_add_u32 v12, 0, v2
    v_xor_b32 v13, v12, v27
    v_lshlrev_b32 v13, 4, v13
    v_lshl_add_u32 v18, v12, 8, v13
    v_add_u32 v12, 4, v2
    v_xor_b32 v13, v12, v27
    v_lshlrev_b32 v13, 4, v13
    v_lshl_add_u32 v19, v12, 8, v13
    v_add_u32 v12, 8, v2
    v_xor_b32 v13, v12, v27
    v_lshlrev_b32 v13, 4, v13
    v_lshl_add_u32 v20, v12, 8, v13
    v_add_u32 v12, 12, v2
    v_xor_b32 v13, v12, v27
    v_lshlrev_b32 v13, 4, v13
    v_lshl_add_u32 v21, v12, 8, v13
    v_lshlrev_b32 v9, 6, v4
    v_add_u32 v9, 147456, v9
    s_lshl_b32 s68, s3, 3
    v_add_u32 v8, s68, v9
    v_and_b32 v10, 15, v1
    v_and_b32 v11, 1, v2
    v_xor_b32 v10, v10, v11
    s_mul_i32 s68, s3, 2048
    s_add_u32 s68, s68, 131072
    v_xor_b32 v12, 0, v10
    v_lshl_add_u32 v12, v11, 4, v12
    v_lshlrev_b32 v12, 4, v12
    v_add_u32 v12, 0, v12
    v_add_u32 v138, s68, v12
    v_xor_b32 v12, 2, v10
    v_lshl_add_u32 v12, v11, 4, v12
    v_lshlrev_b32 v12, 4, v12
    v_add_u32 v12, 512, v12
    v_add_u32 v139, s68, v12
    v_xor_b32 v12, 4, v10
    v_lshl_add_u32 v12, v11, 4, v12
    v_lshlrev_b32 v12, 4, v12
    v_add_u32 v12, 1024, v12
    v_add_u32 v140, s68, v12
    v_xor_b32 v12, 6, v10
    v_lshl_add_u32 v12, v11, 4, v12
    v_lshlrev_b32 v12, 4, v12
    v_add_u32 v12, 1536, v12
    v_add_u32 v141, s68, v12
    v_bfe_u32 v10, v1, 3, 2
    v_lshrrev_b32 v12, 5, v1
    v_bfe_u32 v11, v1, 2, 1
    s_lshl_b32 s68, s3, 1
    v_add_u32 v12, s68, v12
    v_lshl_add_u32 v13, v10, 1, v11
    v_xor_b32 v12, v12, v13
    v_lshl_add_u32 v12, v11, 4, v12
    v_mul_u32_u24 v10, 32, v10
    v_add_u32 v12, v12, v10
    v_and_b32 v11, 3, v1
    v_lshlrev_b32 v11, 2, v11
    v_lshl_add_u32 v142, v12, 4, v11
    v_add_u32 v142, 131072, v142
    v_lshrrev_b32 v143, 5, v1
    v_lshlrev_b32 v143, 4, v143
    v_lshl_add_u32 v143, v4, 14, v143
    s_lshl_b32 s71, s71, 1
    s_lshl_b32 s68, s3, 5
    s_add_u32 s71, s71, s68
    s_add_u32 s71, s71, 393216
    s_lshl_b32 s72, s3, 11
    s_add_u32 s72, s72, 262144
    s_add_u32 s73, s72, 16384
    s_waitcnt vmcnt(16)
    v_readfirstlane_b32 s78, v6
    s_add_u32 s78, s78, 0x9e3779b9
    s_cmp_lg_u32 s3, 0
    s_cbranch_scc1 Lxid_19
    v_mov_b32 v36, s99
    v_mov_b32 v37, s78
    v_mov_b32 v38, s99
    v_mov_b32 v39, s78
    s_lshl_b32 s68, s66, 9
    s_lshr_b32 s98, s2, 3
    s_lshl_b32 s98, s98, 4
    s_add_u32 s68, s68, s98
    s_add_u32 s68, s68, 4096
    s_mov_b64 exec, 1
    buffer_store_dwordx4 v[36:39], off, s[44:47], s68 sc1
    s_mov_b64 exec, -1
Lxid_19:
    v_lshlrev_b32 v112, 16, v104
    v_and_b32 v113, 0xffff0000, v104
    v_lshlrev_b32 v114, 16, v105
    v_and_b32 v115, 0xffff0000, v105
    v_lshlrev_b32 v116, 16, v106
    v_and_b32 v117, 0xffff0000, v106
    v_lshlrev_b32 v118, 16, v107
    v_and_b32 v119, 0xffff0000, v107
    v_pk_add_f32 v[72:73], v[112:113], v[114:115]
    v_pk_mul_f32 v[74:75], v[112:113], v[112:113]
    v_pk_add_f32 v[76:77], v[116:117], v[118:119]
    v_pk_fma_f32 v[74:75], v[114:115], v[114:115], v[74:75]
    v_pk_fma_f32 v[74:75], v[116:117], v[116:117], v[74:75]
    v_pk_fma_f32 v[74:75], v[118:119], v[118:119], v[74:75]
    v_pk_add_f32 v[72:73], v[72:73], v[76:77]
    v_add_f32 v76, v72, v73
    v_add_f32 v77, v74, v75
    s_nop 0
    v_add_f32_dpp v76, v76, v76 row_ror:8 row_mask:0xf bank_mask:0xf
    v_add_f32_dpp v77, v77, v77 row_ror:8 row_mask:0xf bank_mask:0xf
    v_mov_b32 v78, v76
    v_mov_b32 v79, v77
    s_nop 0
    v_permlane16_swap_b32 v76, v78
    v_permlane16_swap_b32 v77, v79
    v_add_f32 v76, v76, v78
    v_add_f32 v77, v77, v79
    v_mov_b32 v78, v76
    v_mov_b32 v79, v77
    s_nop 0
    v_permlane32_swap_b32 v76, v78
    v_permlane32_swap_b32 v77, v79
    v_add_f32 v76, v76, v78
    v_add_f32 v77, v77, v79
    s_mov_b64 exec, 0xff
    ds_write_b64 v8, v[76:77]
    s_mov_b64 exec, -1
    s_waitcnt lgkmcnt(0)
    s_barrier
    ds_read_b128 v[72:75], v9 offset:0
    ds_read_b128 v[76:79], v9 offset:16
    ds_read_b128 v[80:83], v9 offset:32
    ds_read_b128 v[84:87], v9 offset:48
    s_waitcnt lgkmcnt(2)
    v_pk_add_f32 v[72:73], v[72:73], v[74:75]
    v_pk_add_f32 v[76:77], v[76:77], v[78:79]
    s_waitcnt lgkmcnt(0)
    v_pk_add_f32 v[80:81], v[80:81], v[82:83]
    v_pk_add_f32 v[84:85], v[84:85], v[86:87]
    v_pk_add_f32 v[72:73], v[72:73], v[76:77]
    v_pk_add_f32 v[80:81], v[80:81], v[84:85]
    v_pk_add_f32 v[156:157], v[72:73], v[80:81]
    v_mul_f32 v152, 0x3b000000, v156
    s_barrier
    v_pk_add_f32 v[88:89], v[112:113], v[152:153] op_sel_hi:[1,0] neg_lo:[0,1] neg_hi:[0,1]
    v_pk_add_f32 v[90:91], v[114:115], v[152:153] op_sel_hi:[1,0] neg_lo:[0,1] neg_hi:[0,1]
    v_pk_add_f32 v[92:93], v[116:117], v[152:153] op_sel_hi:[1,0] neg_lo:[0,1] neg_hi:[0,1]
    v_pk_add_f32 v[94:95], v[118:119], v[152:153] op_sel_hi:[1,0] neg_lo:[0,1] neg_hi:[0,1]
    v_pk_add_f32 v[72:73], v[88:89], v[90:91]
    v_pk_mul_f32 v[74:75], v[88:89], v[88:89]
    v_pk_add_f32 v[76:77], v[92:93], v[94:95]
    v_pk_fma_f32 v[74:75], v[90:91], v[90:91], v[74:75]
    v_pk_fma_f32 v[74:75], v[92:93], v[92:93], v[74:75]
    v_pk_fma_f32 v[74:75], v[94:95], v[94:95], v[74:75]
    v_pk_add_f32 v[72:73], v[72:73], v[76:77]
    v_add_f32 v76, v72, v73
    v_add_f32 v77, v74, v75
    s_nop 0
    v_add_f32_dpp v76, v76, v76 row_ror:8 row_mask:0xf bank_mask:0xf
    v_add_f32_dpp v77, v77, v77 row_ror:8 row_mask:0xf bank_mask:0xf
    v_mov_b32 v78, v76
    v_mov_b32 v79, v77
    s_nop 0
    v_permlane16_swap_b32 v76, v78
    v_permlane16_swap_b32 v77, v79
    v_add_f32 v76, v76, v78
    v_add_f32 v77, v77, v79
    v_mov_b32 v78, v76
    v_mov_b32 v79, v77
    s_nop 0
    v_permlane32_swap_b32 v76, v78
    v_permlane32_swap_b32 v77, v79
    v_add_f32 v76, v76, v78
    v_add_f32 v77, v77, v79
    s_mov_b64 exec, 0xff
    ds_write_b64 v8, v[76:77]
    s_mov_b64 exec, -1
    s_waitcnt lgkmcnt(0)
    s_barrier
    ds_read_b128 v[72:75], v9 offset:0
    ds_read_b128 v[76:79], v9 offset:16
    ds_read_b128 v[80:83], v9 offset:32
    ds_read_b128 v[84:87], v9 offset:48
    s_waitcnt lgkmcnt(2)
    v_pk_add_f32 v[72:73], v[72:73], v[74:75]
    v_pk_add_f32 v[76:77], v[76:77], v[78:79]
    s_waitcnt lgkmcnt(0)
    v_pk_add_f32 v[80:81], v[80:81], v[82:83]
    v_pk_add_f32 v[84:85], v[84:85], v[86:87]
    v_pk_add_f32 v[72:73], v[72:73], v[76:77]
    v_pk_add_f32 v[80:81], v[80:81], v[84:85]
    v_pk_add_f32 v[156:157], v[72:73], v[80:81]
    v_mov_b32 v154, v152
    v_mul_f32 v156, 0x3b000000, v156
    v_mul_f32 v157, 0x3b000000, v157
    v_fma_f32 v157, -v156, v156, v157
    v_add_f32 v156, v156, v154
    v_max_f32 v157, 0, v157
    v_cvt_pk_bf16_f32 v152, 0, v156
    v_cvt_pk_bf16_f32 v157, 0, v157
    v_add_f32 v157, 0x3727c5ac, v157
    v_cvt_pk_bf16_f32 v157, 0, v157
    v_sqrt_f32 v157, v157
    s_nop 0
    v_cvt_pk_bf16_f32 v157, 0, v157
    v_rcp_f32 v154, v157
    v_pk_add_f32 v[112:113], v[112:113], v[152:153] op_sel_hi:[1,0] neg_lo:[0,1] neg_hi:[0,1]
    v_pk_add_f32 v[114:115], v[114:115], v[152:153] op_sel_hi:[1,0] neg_lo:[0,1] neg_hi:[0,1]
    v_pk_add_f32 v[116:117], v[116:117], v[152:153] op_sel_hi:[1,0] neg_lo:[0,1] neg_hi:[0,1]
    v_pk_add_f32 v[118:119], v[118:119], v[152:153] op_sel_hi:[1,0] neg_lo:[0,1] neg_hi:[0,1]
    v_cvt_pk_bf16_f32 v112, 0, v112
    v_cvt_pk_bf16_f32 v113, 0, v113
    v_cvt_pk_bf16_f32 v114, 0, v114
    v_cvt_pk_bf16_f32 v115, 0, v115
    v_cvt_pk_bf16_f32 v116, 0, v116
    v_cvt_pk_bf16_f32 v117, 0, v117
    v_cvt_pk_bf16_f32 v118, 0, v118
    v_cvt_pk_bf16_f32 v119, 0, v119
    v_pk_mul_f32 v[112:113], v[112:113], v[154:155] op_sel_hi:[1,0]
    v_pk_mul_f32 v[114:115], v[114:115], v[154:155] op_sel_hi:[1,0]
    v_pk_mul_f32 v[116:117], v[116:117], v[154:155] op_sel_hi:[1,0]
    v_pk_mul_f32 v[118:119], v[118:119], v[154:155] op_sel_hi:[1,0]
    v_cvt_pk_bf16_f32 v112, 0, v112
    v_cvt_pk_bf16_f32 v113, 0, v113
    v_cvt_pk_bf16_f32 v114, 0, v114
    v_cvt_pk_bf16_f32 v115, 0, v115
    v_cvt_pk_bf16_f32 v116, 0, v116
    v_cvt_pk_bf16_f32 v117, 0, v117
    v_cvt_pk_bf16_f32 v118, 0, v118
    v_cvt_pk_bf16_f32 v119, 0, v119
    v_mov_b32 v149, s78
    v_mov_b32 v151, s78
    s_add_u32 s7, s4, 0
    s_add_u32 m0, s6, 0
    s_nop 0
    buffer_load_dwordx4 v18, s[60:63], s7 offen nt lds
    s_add_u32 m0, s6, 1024
    s_nop 0
    buffer_load_dwordx4 v19, s[60:63], s7 offen nt lds
    s_add_u32 m0, s6, 2048
    s_nop 0
    buffer_load_dwordx4 v20, s[60:63], s7 offen nt lds
    s_add_u32 m0, s6, 3072
    s_nop 0
    buffer_load_dwordx4 v21, s[60:63], s7 offen nt lds
    v_add_u32 v12, 0, v2
    v_xor_b32 v12, v12, v27
    v_lshlrev_b32 v12, 4, v12
    v_lshl_add_u32 v12, v27, 8, v12
    v_add_u32 v22, s6, v12
    v_add_u32 v12, 4, v2
    v_xor_b32 v12, v12, v27
    v_lshlrev_b32 v12, 4, v12
    v_lshl_add_u32 v12, v27, 8, v12
    v_add_u32 v23, s6, v12
    v_add_u32 v12, 8, v2
    v_xor_b32 v12, v12, v27
    v_lshlrev_b32 v12, 4, v12
    v_lshl_add_u32 v12, v27, 8, v12
    v_add_u32 v24, s6, v12
    v_add_u32 v12, 12, v2
    v_xor_b32 v12, v12, v27
    v_lshlrev_b32 v12, 4, v12
    v_lshl_add_u32 v12, v27, 8, v12
    v_add_u32 v25, s6, v12
    v_lshlrev_b32 v28, 10, v2
    v_lshl_add_u32 v28, v27, 4, v28
    v_and_b32 v12, 3, v1
    v_lshlrev_b32 v13, 8, v12
    v_lshl_add_u32 v26, v2, 4, v13
    v_add_u32 v26, 147456, v26
    v_lshlrev_b32 v33, 5, v12
    v_add_u32 v33, 148480, v33
    s_lshl_b32 s68, s3, 11
    s_add_u32 s68, s68, 131072
    v_add_u32 v13, 0, v2
    v_xor_b32 v13, v13, v4
    v_lshl_add_u32 v13, v27, 3, v13
    v_lshlrev_b32 v13, 4, v13
    v_add_u32 v29, s68, v13
    v_add_u32 v13, 4, v2
    v_xor_b32 v13, v13, v4
    v_lshl_add_u32 v13, v27, 3, v13
    v_lshlrev_b32 v13, 4, v13
    v_add_u32 v30, s68, v13
    s_and_b32 s68, s3, 3
    s_lshl_b32 s68, s68, 2
    s_add_u32 s68, s68, 131072
    v_bfe_u32 v14, v1, 2, 3
    v_lshl_add_u32 v13, v1, 1, 0
    v_xor_b32 v13, v13, v14
    v_lshlrev_b32 v13, 4, v13
    v_add_u32 v31, s68, v13
    v_lshl_add_u32 v13, v1, 1, 1
    v_xor_b32 v13, v13, v14
    v_lshlrev_b32 v13, 4, v13
    v_add_u32 v32, s68, v13
    v_lshlrev_b32 v27, 3, v1
    v_add_u32 v27, 147456, v27
    s_waitcnt vmcnt(4)
    v_perm_b32 v72, v42, v40, s64
    v_perm_b32 v76, v42, v40, s65
    v_perm_b32 v80, v43, v41, s64
    v_perm_b32 v84, v43, v41, s65
    v_perm_b32 v73, v46, v44, s64
    v_perm_b32 v77, v46, v44, s65
    v_perm_b32 v81, v47, v45, s64
    v_perm_b32 v85, v47, v45, s65
    v_perm_b32 v74, v50, v48, s64
    v_perm_b32 v78, v50, v48, s65
    v_perm_b32 v82, v51, v49, s64
    v_perm_b32 v86, v51, v49, s65
    v_perm_b32 v75, v54, v52, s64
    v_perm_b32 v79, v54, v52, s65
    v_perm_b32 v83, v55, v53, s64
    v_perm_b32 v87, v55, v53, s65
    v_perm_b32 v88, v58, v56, s64
    v_perm_b32 v92, v58, v56, s65
    v_perm_b32 v96, v59, v57, s64
    v_perm_b32 v100, v59, v57, s65
    v_perm_b32 v89, v62, v60, s64
    v_perm_b32 v93, v62, v60, s65
    v_perm_b32 v97, v63, v61, s64
    v_perm_b32 v101, v63, v61, s65
    v_perm_b32 v90, v66, v64, s64
    v_perm_b32 v94, v66, v64, s65
    v_perm_b32 v98, v67, v65, s64
    v_perm_b32 v102, v67, v65, s65
    v_perm_b32 v91, v70, v68, s64
    v_perm_b32 v95, v70, v68, s65
    v_perm_b32 v99, v71, v69, s64
    v_perm_b32 v103, v71, v69, s65
    s_waitcnt vmcnt(3)
    s_add_u32 s7, s4, 32768
    s_add_u32 m0, s6, 4096
    s_nop 0
    buffer_load_dwordx4 v18, s[60:63], s7 offen nt lds
    s_waitcnt vmcnt(3)
    s_add_u32 m0, s6, 5120
    s_nop 0
    buffer_load_dwordx4 v19, s[60:63], s7 offen nt lds
    s_waitcnt vmcnt(3)
    s_add_u32 m0, s6, 6144
    s_nop 0
    buffer_load_dwordx4 v20, s[60:63], s7 offen nt lds
    s_waitcnt vmcnt(3)
    s_add_u32 m0, s6, 7168
    s_nop 0
    buffer_load_dwordx4 v21, s[60:63], s7 offen nt lds
    v_lshlrev_b32 v144, 14, v1
    s_lshl_b32 s74, s69, 8
    s_add_u32 s74, s74, s72
    s_mov_b64 exec, 3
    s_mov_b32 s79, 0
Lpoll_21:
    buffer_load_dwordx4 v[40:43], v144, s[44:47], s74 offen sc1
    s_waitcnt vmcnt(0)
    v_min_u32 v10, v41, v43
    v_max_u32 v11, v41, v43
    v_xor_b32 v10, s78, v10
    v_xor_b32 v11, s78, v11
    v_or_b32 v10, v10, v11
    v_cmp_ne_u32 vcc, 0, v10
    s_cbranch_vccz Ldone_22
    s_sleep 2
    s_add_u32 s79, s79, 1
    s_cmp_lt_u32 s79, 400000
    s_cbranch_scc1 Lpoll_21
Ldone_22:
    s_mov_b64 exec, -1
    s_lshl_b32 s68, s66, 9
    s_add_u32 s68, s68, 4096
    v_and_b32 v10, 0x1f0, v7
    buffer_load_dwordx4 v[36:39], v10, s[44:47], s68 offen sc1
    buffer_load_dwordx4 v[40:43], v7, s[44:47], s72 offen offset:0 sc1
    buffer_load_dwordx4 v[44:47], v7, s[44:47], s72 offen offset:1024 sc1
    buffer_load_dwordx4 v[48:51], v7, s[44:47], s73 offen offset:0 sc1
    buffer_load_dwordx4 v[52:55], v7, s[44:47], s73 offen offset:1024 sc1
    s_waitcnt vmcnt(0)
    v_min3_u32 v10, v41, v43, v45
    v_min3_u32 v10, v10, v47, v49
    v_min3_u32 v10, v10, v51, v53
    v_min_u32 v10, v10, v55
    v_max3_u32 v11, v41, v43, v45
    v_max3_u32 v11, v11, v47, v49
    v_max3_u32 v11, v11, v51, v53
    v_max_u32 v11, v11, v55
    v_xor_b32 v10, s78, v10
    v_xor_b32 v11, s78, v11
    v_or_b32 v10, v10, v11
    v_cmp_ne_u32 vcc, 0, v10
    s_cbranch_vccz Lmo_20
    s_mov_b32 s79, 0
Lpoll_23:
    buffer_load_dwordx4 v[40:43], v7, s[44:47], s72 offen offset:0 sc1
    buffer_load_dwordx4 v[44:47], v7, s[44:47], s72 offen offset:1024 sc1
    buffer_load_dwordx4 v[48:51], v7, s[44:47], s73 offen offset:0 sc1
    buffer_load_dwordx4 v[52:55], v7, s[44:47], s73 offen offset:1024 sc1
    s_waitcnt vmcnt(0)
    v_min3_u32 v10, v41, v43, v45
    v_min3_u32 v10, v10, v47, v49
    v_min3_u32 v10, v10, v51, v53
    v_min_u32 v10, v10, v55
    v_max3_u32 v11, v41, v43, v45
    v_max3_u32 v11, v11, v47, v49
    v_max3_u32 v11, v11, v51, v53
    v_max_u32 v11, v11, v55
    v_xor_b32 v10, s78, v10
    v_xor_b32 v11, s78, v11
    v_or_b32 v10, v10, v11
    v_cmp_ne_u32 vcc, 0, v10
    s_cbranch_vccz Ldone_24
    s_sleep 2
    s_add_u32 s79, s79, 1
    s_cmp_lt_u32 s79, 400000
    s_cbranch_scc1 Lpoll_23
Ldone_24:
Lmo_20:
    v_lshlrev_b32 v120, 16, v48
    v_and_b32 v121, 0xffff0000, v48
    v_lshlrev_b32 v122, 16, v50
    v_and_b32 v123, 0xffff0000, v50
    v_lshlrev_b32 v124, 16, v52
    v_and_b32 v125, 0xffff0000, v52
    v_lshlrev_b32 v126, 16, v54
    v_and_b32 v127, 0xffff0000, v54
    v_pk_add_f32 v[120:121], v[120:121], 1.0 op_sel_hi:[1,0]
    v_pk_add_f32 v[122:123], v[122:123], 1.0 op_sel_hi:[1,0]
    v_pk_add_f32 v[124:125], v[124:125], 1.0 op_sel_hi:[1,0]
    v_pk_add_f32 v[126:127], v[126:127], 1.0 op_sel_hi:[1,0]
    v_cvt_pk_bf16_f32 v120, 0, v120
    v_cvt_pk_bf16_f32 v121, 0, v121
    v_cvt_pk_bf16_f32 v122, 0, v122
    v_cvt_pk_bf16_f32 v123, 0, v123
    v_cvt_pk_bf16_f32 v124, 0, v124
    v_cvt_pk_bf16_f32 v125, 0, v125
    v_cvt_pk_bf16_f32 v126, 0, v126
    v_cvt_pk_bf16_f32 v127, 0, v127
    v_lshlrev_b32 v128, 16, v40
    v_and_b32 v129, 0xffff0000, v40
    v_lshlrev_b32 v130, 16, v42
    v_and_b32 v131, 0xffff0000, v42
    v_lshlrev_b32 v132, 16, v44
    v_and_b32 v133, 0xffff0000, v44
    v_lshlrev_b32 v134, 16, v46
    v_and_b32 v135, 0xffff0000, v46
    v_pk_mul_f32 v[112:113], v[112:113], v[120:121]
    v_pk_mul_f32 v[114:115], v[114:115], v[122:123]
    v_pk_mul_f32 v[116:117], v[116:117], v[124:125]
    v_pk_mul_f32 v[118:119], v[118:119], v[126:127]
    v_cvt_pk_bf16_f32 v112, 0, v112
    v_cvt_pk_bf16_f32 v113, 0, v113
    v_cvt_pk_bf16_f32 v114, 0, v114
    v_cvt_pk_bf16_f32 v115, 0, v115
    v_cvt_pk_bf16_f32 v116, 0, v116
    v_cvt_pk_bf16_f32 v117, 0, v117
    v_cvt_pk_bf16_f32 v118, 0, v118
    v_cvt_pk_bf16_f32 v119, 0, v119
    v_pk_add_f32 v[112:113], v[112:113], v[128:129]
    v_pk_add_f32 v[114:115], v[114:115], v[130:131]
    v_pk_add_f32 v[116:117], v[116:117], v[132:133]
    v_pk_add_f32 v[118:119], v[118:119], v[134:135]
    v_cvt_pk_bf16_f32 v104, v112, v113
    v_cvt_pk_bf16_f32 v105, v114, v115
    v_cvt_pk_bf16_f32 v106, v116, v117
    v_cvt_pk_bf16_f32 v107, v118, v119
    v_mov_b32_dpp v108, v104 row_ror:8 row_mask:0xf bank_mask:0xf
    v_mov_b32_dpp v109, v105 row_ror:8 row_mask:0xf bank_mask:0xf
    v_mov_b32_dpp v110, v106 row_ror:8 row_mask:0xf bank_mask:0xf
    v_mov_b32_dpp v111, v107 row_ror:8 row_mask:0xf bank_mask:0xf
    v_mfma_f32_16x16x32_bf16 v[56:59], v[104:107], v[72:75], 0
    v_mfma_f32_16x16x32_bf16 v[60:63], v[104:107], v[76:79], 0
    v_mfma_f32_16x16x32_bf16 v[64:67], v[104:107], v[80:83], 0
    v_mfma_f32_16x16x32_bf16 v[68:71], v[104:107], v[84:87], 0
    v_mfma_f32_16x16x32_bf16 v[56:59], v[108:111], v[88:91], v[56:59]
    v_mfma_f32_16x16x32_bf16 v[60:63], v[108:111], v[92:95], v[60:63]
    v_mfma_f32_16x16x32_bf16 v[64:67], v[108:111], v[96:99], v[64:67]
    v_mfma_f32_16x16x32_bf16 v[68:71], v[108:111], v[100:103], v[68:71]
    v_xor_b32 v10, s99, v36
    v_xor_b32 v11, s78, v37
    v_xor_b32 v12, s99, v38
    v_xor_b32 v13, s78, v39
    v_or3_b32 v10, v10, v11, v12
    v_or_b32 v10, v10, v13
    v_cmp_ne_u32 vcc, 0, v10
    s_cmp_eq_u64 vcc, 0
    s_cselect_b32 s98, 1, 0
    s_mov_b32 exec_lo, 0xffffffff
    s_mov_b32 exec_hi, 0x0
    ds_write_b128 v138, v[56:59]
    ds_write_b128 v139, v[60:63]
    ds_write_b128 v140, v[64:67]
    ds_write_b128 v141, v[68:71]
    s_mov_b64 exec, -1
    s_waitcnt lgkmcnt(0)
    s_barrier
    ds_read2st64_b32 v[40:41], v142 offset0:0 offset1:8
    ds_read2st64_b32 v[42:43], v142 offset0:16 offset1:24
    ds_read2st64_b32 v[44:45], v142 offset0:32 offset1:40
    ds_read2st64_b32 v[46:47], v142 offset0:48 offset1:56
    s_waitcnt lgkmcnt(2)
    v_pk_add_f32 v[40:41], v[40:41], v[42:43]
    s_waitcnt lgkmcnt(1)
    v_pk_add_f32 v[40:41], v[40:41], v[44:45]
    s_waitcnt lgkmcnt(0)
    v_pk_add_f32 v[40:41], v[40:41], v[46:47]
    v_add_f32 v112, v40, v41
    s_nop 1
    v_mov_b32_dpp v113, v112 row_ror:8 row_mask:0xf bank_mask:0xf
    v_cvt_pk_bf16_f32 v148, v112, v113
    v_cvt_pk_bf16_f32 v150, v112, v113
    s_nop 1
    v_permlane16_swap_b32 v148, v150
    s_mov_b32 exec_lo, 0xff
    s_mov_b32 exec_hi, 0xff
    s_cmp_eq_u32 s98, 1
    s_cbranch_scc1 Lst_25
    buffer_store_dwordx4 v[148:151], v143, s[44:47], s71 offen sc1
    s_branch Lse_26
Lst_25:
    buffer_store_dwordx4 v[148:151], v143, s[44:47], s71 offen
Lse_26:
    s_mov_b64 exec, -1
    s_waitcnt vmcnt(5)
    s_add_u32 s7, s4, 65536
    s_add_u32 m0, s6, 8192
    s_nop 0
    buffer_load_dwordx4 v18, s[60:63], s7 offen nt lds
    s_waitcnt vmcnt(5)
    s_add_u32 m0, s6, 9216
    s_nop 0
    buffer_load_dwordx4 v19, s[60:63], s7 offen nt lds
    s_waitcnt vmcnt(5)
    s_add_u32 m0, s6, 10240
    s_nop 0
    buffer_load_dwordx4 v20, s[60:63], s7 offen nt lds
    s_waitcnt vmcnt(5)
    s_add_u32 m0, s6, 11264
    s_nop 0
    buffer_load_dwordx4 v21, s[60:63], s7 offen nt lds
    s_waitcnt vmcnt(5)
    s_add_u32 s7, s4, 98304
    s_add_u32 m0, s6, 12288
    s_nop 0
    buffer_load_dwordx4 v18, s[60:63], s7 offen nt lds
    s_waitcnt vmcnt(5)
    s_add_u32 m0, s6, 13312
    s_nop 0
    buffer_load_dwordx4 v19, s[60:63], s7 offen nt lds
    s_waitcnt vmcnt(5)
    s_add_u32 m0, s6, 14336
    s_nop 0
    buffer_load_dwordx4 v20, s[60:63], s7 offen nt lds
    s_waitcnt vmcnt(5)
    s_add_u32 m0, s6, 15360
    s_nop 0
    buffer_load_dwordx4 v21, s[60:63], s7 offen nt lds
    s_mov_b32 s5, 3
L_VS:
    s_cmp_eq_u32 s5, 2
    s_cbranch_scc1 L_HV
    s_cmp_lg_u32 s5, 0
    s_cbranch_scc1 Lf_27
    s_waitcnt vmcnt(2)
Lf_27:
    s_cmp_eq_u32 s5, 3
    s_cbranch_scc1 Lf_28
    s_waitcnt vmcnt(3)
Lf_28:
    s_waitcnt vmcnt(5)
    s_add_u32 s7, s4, 0
    buffer_load_dwordx4 v[40:43], v28, s[56:59], s7 offen offset:0 nt
    s_cmp_lg_u32 s5, 0
    s_cbranch_scc1 Lf_29
    s_waitcnt vmcnt(2)
Lf_29:
    s_cmp_eq_u32 s5, 3
    s_cbranch_scc1 Lf_30
    s_waitcnt vmcnt(3)
Lf_30:
    s_waitcnt vmcnt(5)
    s_add_u32 s7, s4, 0
    buffer_load_dwordx4 v[44:47], v28, s[56:59], s7 offen offset:256 nt
    s_cmp_lg_u32 s5, 0
    s_cbranch_scc1 Lf_31
    s_waitcnt vmcnt(2)
Lf_31:
    s_cmp_eq_u32 s5, 3
    s_cbranch_scc1 Lf_32
    s_waitcnt vmcnt(3)
Lf_32:
    s_waitcnt vmcnt(5)
    s_add_u32 s7, s4, 0
    buffer_load_dwordx4 v[48:51], v28, s[56:59], s7 offen offset:512 nt
    s_cmp_lg_u32 s5, 0
    s_cbranch_scc1 Lf_33
    s_waitcnt vmcnt(2)
Lf_33:
    s_cmp_eq_u32 s5, 3
    s_cbranch_scc1 Lf_34
    s_waitcnt vmcnt(3)
Lf_34:
    s_waitcnt vmcnt(5)
    s_add_u32 s7, s4, 0
    buffer_load_dwordx4 v[52:55], v28, s[56:59], s7 offen offset:768 nt
    s_lshl_b32 s68, s66, 9
    s_add_u32 s68, s68, 4096
    v_and_b32 v10, 0x1f0, v7
    buffer_load_dwordx4 v[36:39], v10, s[44:47], s68 offen sc1
    s_cmp_lg_u32 s5, 0
    s_cbranch_scc1 Lf_35
    s_waitcnt vmcnt(2)
Lf_35:
    s_cmp_eq_u32 s5, 3
    s_cbranch_scc1 Lf_36
    s_waitcnt vmcnt(3)
Lf_36:
    s_waitcnt vmcnt(5)
    s_add_u32 s7, s4, 32768
    buffer_load_dwordx4 v[56:59], v28, s[56:59], s7 offen offset:0 nt
    s_waitcnt vmcnt(5)
    ds_read_b128 v[136:139], v22 offset:0
    ds_read_b128 v[140:143], v23 offset:0
    ds_read_b128 v[144:147], v24 offset:0
    ds_read_b128 v[148:151], v25 offset:0
    ds_read_b128 v[152:155], v22 offset:4096
    ds_read_b128 v[156:159], v23 offset:4096
    ds_read_b128 v[160:163], v24 offset:4096
    ds_read_b128 v[164:167], v25 offset:4096
    ds_read_b128 v[168:171], v22 offset:8192
    ds_read_b128 v[172:175], v23 offset:8192
    ds_read_b128 v[176:179], v24 offset:8192
    ds_read_b128 v[180:183], v25 offset:8192
    s_waitcnt lgkmcnt(4)
    ds_read_b128 v[184:187], v22 offset:12288
    ds_read_b128 v[188:191], v23 offset:12288
    ds_read_b128 v[192:195], v24 offset:12288
    ds_read_b128 v[196:199], v25 offset:12288
    s_lshl_b32 s9, s8, 11
    s_add_u32 s9, s9, 393216
    s_cmp_lg_u32 s3, 0
    s_cbranch_scc1 Lqp_37
    buffer_load_dwordx4 v[232:235], v7, s[44:47], s9 offen offset:0 sc1
    buffer_load_dwordx4 v[236:239], v7, s[44:47], s9 offen offset:1024 sc1
Lqp_37:
    s_cmp_lg_u32 s5, 0
    s_cbranch_scc1 Lf_38
    s_waitcnt vmcnt(2)
Lf_38:
    s_cmp_eq_u32 s5, 3
    s_cbranch_scc1 Lf_39
    s_waitcnt vmcnt(3)
Lf_39:
    s_waitcnt vmcnt(5)
    s_add_u32 s7, s4, 32768
    buffer_load_dwordx4 v[60:63], v28, s[56:59], s7 offen offset:256 nt
    s_cmp_lg_u32 s5, 0
    s_cbranch_scc1 Lf_40
    s_waitcnt vmcnt(2)
Lf_40:
    s_cmp_eq_u32 s5, 3
    s_cbranch_scc1 Lf_41
    s_waitcnt vmcnt(3)
Lf_41:
    s_waitcnt vmcnt(5)
    s_add_u32 s7, s4, 32768
    buffer_load_dwordx4 v[64:67], v28, s[56:59], s7 offen offset:512 nt
    s_cmp_lg_u32 s5, 0
    s_cbranch_scc1 Lf_42
    s_waitcnt vmcnt(2)
Lf_42:
    s_cmp_eq_u32 s5, 3
    s_cbranch_scc1 Lf_43
    s_waitcnt vmcnt(3)
Lf_43:
    s_waitcnt vmcnt(5)
    s_add_u32 s7, s4, 32768
    buffer_load_dwordx4 v[68:71], v28, s[56:59], s7 offen offset:768 nt
    s_cmp_lg_u32 s5, 0
    s_cbranch_scc1 Lf_44
    s_waitcnt vmcnt(2)
Lf_44:
    s_cmp_eq_u32 s5, 3
    s_cbranch_scc1 Lf_45
    s_waitcnt vmcnt(3)
Lf_45:
    s_waitcnt vmcnt(5)
    s_add_u32 s7, s4, 65536
    buffer_load_dwordx4 v[72:75], v28, s[56:59], s7 offen offset:0 nt
    s_cmp_lg_u32 s3, 0
    s_cbranch_scc1 Lq_46
    s_waitcnt vmcnt(4)
    v_min3_u32 v10, v233, v235, v237
    v_min_u32 v10, v10, v239
    v_max3_u32 v11, v233, v235, v237
    v_max_u32 v11, v11, v239
    v_xor_b32 v10, s78, v10
    v_xor_b32 v11, s78, v11
    v_or_b32 v10, v10, v11
    v_cmp_ne_u32 vcc, 0, v10
    s_cbranch_vccz Lq_47
    s_mov_b32 s79, 0
Lpoll_48:
    buffer_load_dwordx4 v[232:235], v7, s[44:47], s9 offen offset:0 sc1
    buffer_load_dwordx4 v[236:239], v7, s[44:47], s9 offen offset:1024 sc1
    s_waitcnt vmcnt(0)
    v_min3_u32 v10, v233, v235, v237
    v_min_u32 v10, v10, v239
    v_max3_u32 v11, v233, v235, v237
    v_max_u32 v11, v11, v239
    v_xor_b32 v10, s78, v10
    v_xor_b32 v11, s78, v11
    v_or_b32 v10, v10, v11
    v_cmp_ne_u32 vcc, 0, v10
    s_cbranch_vccz Ldone_49
    s_sleep 2
    s_add_u32 s79, s79, 1
    s_cmp_lt_u32 s79, 400000
    s_cbranch_scc1 Lpoll_48
Ldone_49:
Lq_47:
    ds_write2_b32 v27, v232, v234 offset0:0 offset1:1
    ds_write2_b32 v27, v236, v238 offset0:128 offset1:129
Lq_46:
    s_lshl_b32 s68, s3, 2
    v_add_u32 v16, s68, v33
    s_waitcnt lgkmcnt(0)
    s_barrier
    ds_read_b128 v[200:203], v26 offset:0
    ds_read_b128 v[204:207], v26 offset:64
    ds_read_b128 v[208:211], v26 offset:128
    ds_read_b128 v[212:215], v26 offset:192
    s_add_u32 s7, s4, 65536
    buffer_load_dwordx4 v[76:79], v28, s[56:59], s7 offen offset:256 nt
    s_add_u32 s7, s4, 65536
    buffer_load_dwordx4 v[80:83], v28, s[56:59], s7 offen offset:512 nt
    s_waitcnt lgkmcnt(3)
    v_mfma_f32_16x16x32_bf16 v[216:219], v[136:139], v[200:203], 0
    v_mfma_f32_16x16x32_bf16 v[220:223], v[152:155], v[200:203], 0
    v_mfma_f32_16x16x32_bf16 v[224:227], v[168:171], v[200:203], 0
    v_mfma_f32_16x16x32_bf16 v[228:231], v[184:187], v[200:203], 0
    s_waitcnt lgkmcnt(2)
    v_mfma_f32_16x16x32_bf16 v[216:219], v[140:143], v[204:207], v[216:219]
    v_mfma_f32_16x16x32_bf16 v[220:223], v[156:159], v[204:207], v[220:223]
    v_mfma_f32_16x16x32_bf16 v[224:227], v[172:175], v[204:207], v[224:227]
    v_mfma_f32_16x16x32_bf16 v[228:231], v[188:191], v[204:207], v[228:231]
    s_waitcnt lgkmcnt(1)
    v_mfma_f32_16x16x32_bf16 v[216:219], v[144:147], v[208:211], v[216:219]
    v_mfma_f32_16x16x32_bf16 v[220:223], v[160:163], v[208:211], v[220:223]
    v_mfma_f32_16x16x32_bf16 v[224:227], v[176:179], v[208:211], v[224:227]
    v_mfma_f32_16x16x32_bf16 v[228:231], v[192:195], v[208:211], v[228:231]
    s_waitcnt lgkmcnt(0)
    v_mfma_f32_16x16x32_bf16 v[216:219], v[148:151], v[212:215], v[216:219]
    v_mfma_f32_16x16x32_bf16 v[220:223], v[164:167], v[212:215], v[220:223]
    v_mfma_f32_16x16x32_bf16 v[224:227], v[180:183], v[212:215], v[224:227]
    v_mfma_f32_16x16x32_bf16 v[228:231], v[196:199], v[212:215], v[228:231]
    s_add_u32 s7, s4, 65536
    buffer_load_dwordx4 v[84:87], v28, s[56:59], s7 offen offset:768 nt
    s_mov_b32 exec_lo, 0xf000f0
    s_mov_b32 exec_hi, 0xf000f0
    s_nop 1
    v_mov_b32 v216, v220
    v_mov_b32 v217, v221
    v_mov_b32 v218, v222
    v_mov_b32 v219, v223
    s_mov_b32 exec_lo, 0xf000f00
    s_mov_b32 exec_hi, 0xf000f00
    v_mov_b32 v216, v224
    v_mov_b32 v217, v225
    v_mov_b32 v218, v226
    v_mov_b32 v219, v227
    s_mov_b32 exec_lo, 0xf000f000
    s_mov_b32 exec_hi, 0xf000f000
    v_mov_b32 v216, v228
    v_mov_b32 v217, v229
    v_mov_b32 v218, v230
    v_mov_b32 v219, v231
    s_mov_b64 exec, -1
    v_cvt_pk_bf16_f32 v216, 0, v216
    v_cvt_pk_bf16_f32 v217, 0, v217
    v_cvt_pk_bf16_f32 v218, 0, v218
    v_cvt_pk_bf16_f32 v219, 0, v219
    v_mul_f32 v216, 0x3db504f3, v216
    v_mul_f32 v217, 0x3db504f3, v217
    v_mul_f32 v218, 0x3db504f3, v218
    v_mul_f32 v219, 0x3db504f3, v219
    v_cvt_pk_bf16_f32 v216, 0, v216
    v_cvt_pk_bf16_f32 v217, 0, v217
    v_cvt_pk_bf16_f32 v218, 0, v218
    v_cvt_pk_bf16_f32 v219, 0, v219
    v_max_f32 v236, v216, v217
    v_max3_f32 v236, v236, v218, v219
    s_nop 1
    v_max_f32_dpp v236, v236, v236 row_ror:4 row_mask:0xf bank_mask:0xf
    s_nop 1
    v_max_f32_dpp v236, v236, v236 row_ror:8 row_mask:0xf bank_mask:0xf
    v_mov_b32 v14, v236
    s_nop 1
    v_permlane16_swap_b32 v236, v14
    v_max_f32 v236, v236, v14
    v_mov_b32 v14, v236
    s_nop 1
    v_permlane32_swap_b32 v236, v14
    v_max_f32 v236, v236, v14
    s_mov_b64 exec, 0xf
    ds_write_b32 v16, v236
    s_mov_b64 exec, -1
    v_mov_b32 v17, 0x3fb8aa3b
    v_mov_b32 v136, 0
    v_mov_b32 v137, 0
    v_mov_b32 v138, 0
    v_mov_b32 v139, 0
    v_mov_b32 v140, 0
    v_mov_b32 v141, 0
    v_mov_b32 v142, 0
    v_mov_b32 v143, 0
    v_mov_b32 v144, 0
    v_mov_b32 v145, 0
    v_mov_b32 v146, 0
    v_mov_b32 v147, 0
    v_mov_b32 v148, 0
    v_mov_b32 v149, 0
    v_mov_b32 v150, 0
    v_mov_b32 v151, 0
    v_mov_b32 v152, 0
    v_mov_b32 v153, 0
    v_mov_b32 v154, 0
    v_mov_b32 v155, 0
    v_mov_b32 v156, 0
    v_mov_b32 v157, 0
    v_mov_b32 v158, 0
    v_mov_b32 v159, 0
    v_mov_b32 v160, 0
    v_mov_b32 v161, 0
    v_mov_b32 v162, 0
    v_mov_b32 v163, 0
    v_mov_b32 v164, 0
    v_mov_b32 v165, 0
    v_mov_b32 v166, 0
    v_mov_b32 v167, 0
    s_waitcnt lgkmcnt(0)
    s_add_u32 s7, s4, 98304
    buffer_load_dwordx4 v[88:91], v28, s[56:59], s7 offen offset:0 nt
    s_barrier
    ds_read_b128 v[184:187], v33
    ds_read_b128 v[188:191], v33 offset:16
    s_waitcnt lgkmcnt(0)
    v_max3_f32 v236, v184, v185, v186
    v_max3_f32 v13, v187, v188, v189
    v_max3_f32 v236, v236, v190, v191
    v_max_f32 v236, v236, v13
    v_mul_f32 v236, v236, v17
    v_fma_f32 v216, v216, v17, -v236
    v_fma_f32 v217, v217, v17, -v236
    v_fma_f32 v218, v218, v17, -v236
    v_fma_f32 v219, v219, v17, -v236
    v_exp_f32 v216, v216
    v_exp_f32 v217, v217
    v_exp_f32 v218, v218
    v_exp_f32 v219, v219
    v_cvt_pk_bf16_f32 v220, v216, v217
    v_cvt_pk_bf16_f32 v221, v218, v219
    v_add_f32 v216, v216, v217
    v_add_f32 v218, v218, v219
    v_add_f32 v13, v216, v218
    s_add_u32 s7, s4, 98304
    buffer_load_dwordx4 v[92:95], v28, s[56:59], s7 offen offset:256 nt
    v_mov_b32_dpp v136, v220 quad_perm:[0,1,2,3] row_mask:0xf bank_mask:0x1
    v_mov_b32_dpp v140, v220 row_ror:4 row_mask:0xf bank_mask:0x2
    v_mov_b32_dpp v144, v220 row_ror:8 row_mask:0xf bank_mask:0x4
    v_mov_b32_dpp v148, v220 row_ror:12 row_mask:0xf bank_mask:0x8
    v_mov_b32_dpp v137, v221 quad_perm:[0,1,2,3] row_mask:0xf bank_mask:0x1
    v_mov_b32_dpp v141, v221 row_ror:4 row_mask:0xf bank_mask:0x2
    v_mov_b32_dpp v145, v221 row_ror:8 row_mask:0xf bank_mask:0x4
    v_mov_b32_dpp v149, v221 row_ror:12 row_mask:0xf bank_mask:0x8
    v_mov_b32_dpp v138, v220 row_ror:12 row_mask:0xf bank_mask:0x1
    v_mov_b32_dpp v142, v220 quad_perm:[0,1,2,3] row_mask:0xf bank_mask:0x2
    v_mov_b32_dpp v146, v220 row_ror:4 row_mask:0xf bank_mask:0x4
    v_mov_b32_dpp v150, v220 row_ror:8 row_mask:0xf bank_mask:0x8
    v_mov_b32_dpp v139, v221 row_ror:12 row_mask:0xf bank_mask:0x1
    v_mov_b32_dpp v143, v221 quad_perm:[0,1,2,3] row_mask:0xf bank_mask:0x2
    v_mov_b32_dpp v147, v221 row_ror:4 row_mask:0xf bank_mask:0x4
    v_mov_b32_dpp v151, v221 row_ror:8 row_mask:0xf bank_mask:0x8
    v_mov_b32_dpp v152, v220 row_ror:8 row_mask:0xf bank_mask:0x1
    v_mov_b32_dpp v156, v220 row_ror:12 row_mask:0xf bank_mask:0x2
    v_mov_b32_dpp v160, v220 quad_perm:[0,1,2,3] row_mask:0xf bank_mask:0x4
    v_mov_b32_dpp v164, v220 row_ror:4 row_mask:0xf bank_mask:0x8
    v_mov_b32_dpp v153, v221 row_ror:8 row_mask:0xf bank_mask:0x1
    v_mov_b32_dpp v157, v221 row_ror:12 row_mask:0xf bank_mask:0x2
    v_mov_b32_dpp v161, v221 quad_perm:[0,1,2,3] row_mask:0xf bank_mask:0x4
    v_mov_b32_dpp v165, v221 row_ror:4 row_mask:0xf bank_mask:0x8
    v_mov_b32_dpp v154, v220 row_ror:4 row_mask:0xf bank_mask:0x1
    v_mov_b32_dpp v158, v220 row_ror:8 row_mask:0xf bank_mask:0x2
    v_mov_b32_dpp v162, v220 row_ror:12 row_mask:0xf bank_mask:0x4
    v_mov_b32_dpp v166, v220 quad_perm:[0,1,2,3] row_mask:0xf bank_mask:0x8
    v_mov_b32_dpp v155, v221 row_ror:4 row_mask:0xf bank_mask:0x1
    v_mov_b32_dpp v159, v221 row_ror:8 row_mask:0xf bank_mask:0x2
    v_mov_b32_dpp v163, v221 row_ror:12 row_mask:0xf bank_mask:0x4
    v_mov_b32_dpp v167, v221 quad_perm:[0,1,2,3] row_mask:0xf bank_mask:0x8
    v_add_f32_dpp v13, v13, v13 row_ror:4 row_mask:0xf bank_mask:0xf
    s_nop 1
    v_add_f32_dpp v13, v13, v13 row_ror:8 row_mask:0xf bank_mask:0xf
    v_mov_b32 v14, v13
    s_nop 1
    v_permlane16_swap_b32 v13, v14
    v_add_f32 v13, v13, v14
    v_mov_b32 v14, v13
    s_nop 1
    v_permlane32_swap_b32 v13, v14
    v_add_f32 v13, v13, v14
    s_mov_b64 exec, 0xf
    ds_write_b32 v16, v13 offset:128
    s_mov_b64 exec, -1
    v_mov_b32 v233, s78
    v_mov_b32 v235, s78
    v_mov_b32 v237, s78
    v_mov_b32 v239, s78
    s_and_b32 s68, s3, 3
    v_readlane_b32 s75, v236, s68
    s_lshl_b32 s68, s68, 5
    s_add_u32 s68, s68, 148608
    v_mov_b32 v33, s68
    v_mov_b32 v236, s75
    s_waitcnt vmcnt(6)
    v_perm_b32 v104, v44, v40, s64
    v_perm_b32 v108, v44, v40, s65
    v_perm_b32 v112, v45, v41, s64
    v_perm_b32 v116, v45, v41, s65
    v_perm_b32 v120, v46, v42, s64
    v_perm_b32 v124, v46, v42, s65
    v_perm_b32 v128, v47, v43, s64
    v_perm_b32 v132, v47, v43, s65
    v_perm_b32 v105, v52, v48, s64
    v_perm_b32 v109, v52, v48, s65
    v_perm_b32 v113, v53, v49, s64
    v_perm_b32 v117, v53, v49, s65
    v_perm_b32 v121, v54, v50, s64
    v_perm_b32 v125, v54, v50, s65
    v_perm_b32 v129, v55, v51, s64
    v_perm_b32 v133, v55, v51, s65
    v_perm_b32 v106, v60, v56, s64
    v_perm_b32 v110, v60, v56, s65
    v_perm_b32 v114, v61, v57, s64
    v_perm_b32 v118, v61, v57, s65
    v_perm_b32 v122, v62, v58, s64
    v_perm_b32 v126, v62, v58, s65
    v_perm_b32 v130, v63, v59, s64
    v_perm_b32 v134, v63, v59, s65
    v_perm_b32 v107, v68, v64, s64
    v_perm_b32 v111, v68, v64, s65
    v_perm_b32 v115, v69, v65, s64
    v_perm_b32 v119, v69, v65, s65
    v_perm_b32 v123, v70, v66, s64
    v_perm_b32 v127, v70, v66, s65
    v_perm_b32 v131, v71, v67, s64
    v_perm_b32 v135, v71, v67, s65
    v_xor_b32 v10, s99, v36
    v_xor_b32 v11, s78, v37
    v_xor_b32 v12, s99, v38
    v_xor_b32 v13, s78, v39
    v_or3_b32 v10, v10, v11, v12
    v_or_b32 v10, v10, v13
    v_cmp_ne_u32 vcc, 0, v10
    s_cmp_eq_u64 vcc, 0
    s_cselect_b32 s98, 1, 0
    s_add_u32 s7, s4, 98304
    buffer_load_dwordx4 v[96:99], v28, s[56:59], s7 offen offset:512 nt
    s_add_u32 s7, s4, 98304
    buffer_load_dwordx4 v[100:103], v28, s[56:59], s7 offen offset:768 nt
    s_mov_b32 s69, 1
    s_branch L_J
L_HV:
    s_waitcnt vmcnt(3)
    s_add_u32 s7, s4, 0
    buffer_load_dwordx4 v[40:43], v28, s[56:59], s7 offen offset:0 nt
    s_waitcnt vmcnt(3)
    s_add_u32 s7, s4, 0
    buffer_load_dwordx4 v[44:47], v28, s[56:59], s7 offen offset:256 nt
    s_waitcnt vmcnt(3)
    s_add_u32 s7, s4, 0
    buffer_load_dwordx4 v[48:51], v28, s[56:59], s7 offen offset:512 nt
    s_waitcnt vmcnt(3)
    s_add_u32 s7, s4, 0
    buffer_load_dwordx4 v[52:55], v28, s[56:59], s7 offen offset:768 nt
    s_lshl_b32 s68, s66, 9
    s_add_u32 s68, s68, 4096
    v_and_b32 v10, 0x1f0, v7
    buffer_load_dwordx4 v[36:39], v10, s[44:47], s68 offen sc1
    s_waitcnt vmcnt(3)
    s_add_u32 s7, s4, 32768
    buffer_load_dwordx4 v[56:59], v28, s[56:59], s7 offen offset:0 nt
    s_waitcnt vmcnt(5)
    ds_read_b128 v[136:139], v22 offset:0
    ds_read_b128 v[140:143], v23 offset:0
    ds_read_b128 v[144:147], v24 offset:0
    ds_read_b128 v[148:151], v25 offset:0
    ds_read_b128 v[152:155], v22 offset:4096
    ds_read_b128 v[156:159], v23 offset:4096
    ds_read_b128 v[160:163], v24 offset:4096
    ds_read_b128 v[164:167], v25 offset:4096
    ds_read_b128 v[168:171], v22 offset:8192
    ds_read_b128 v[172:175], v23 offset:8192
    ds_read_b128 v[176:179], v24 offset:8192
    ds_read_b128 v[180:183], v25 offset:8192
    s_waitcnt lgkmcnt(4)
    ds_read_b128 v[184:187], v22 offset:12288
    ds_read_b128 v[188:191], v23 offset:12288
    ds_read_b128 v[192:195], v24 offset:12288
    ds_read_b128 v[196:199], v25 offset:12288
    s_waitcnt vmcnt(3)
    s_add_u32 s7, s4, 32768
    buffer_load_dwordx4 v[60:63], v28, s[56:59], s7 offen offset:256 nt
    s_waitcnt vmcnt(3)
    s_add_u32 s7, s4, 32768
    buffer_load_dwordx4 v[64:67], v28, s[56:59], s7 offen offset:512 nt
    s_waitcnt vmcnt(3)
    s_add_u32 s7, s4, 32768
    buffer_load_dwordx4 v[68:71], v28, s[56:59], s7 offen offset:768 nt
    s_waitcnt vmcnt(3)
    s_add_u32 s7, s4, 65536
    buffer_load_dwordx4 v[72:75], v28, s[56:59], s7 offen offset:0 nt
    s_waitcnt vmcnt(3)
    s_add_u32 s7, s4, 65536
    buffer_load_dwordx4 v[76:79], v28, s[56:59], s7 offen offset:256 nt
    s_waitcnt vmcnt(3)
    s_add_u32 s7, s4, 65536
    buffer_load_dwordx4 v[80:83], v28, s[56:59], s7 offen offset:512 nt
    s_waitcnt vmcnt(3)
    s_add_u32 s7, s4, 65536
    buffer_load_dwordx4 v[84:87], v28, s[56:59], s7 offen offset:768 nt
    s_waitcnt vmcnt(3)
    s_add_u32 s7, s4, 98304
    buffer_load_dwordx4 v[88:91], v28, s[56:59], s7 offen offset:0 nt
    s_waitcnt vmcnt(3)
    s_add_u32 s7, s4, 98304
    buffer_load_dwordx4 v[92:95], v28, s[56:59], s7 offen offset:256 nt
    s_waitcnt vmcnt(6)
    v_perm_b32 v104, v44, v40, s64
    v_perm_b32 v108, v44, v40, s65
    v_perm_b32 v112, v45, v41, s64
    v_perm_b32 v116, v45, v41, s65
    v_perm_b32 v120, v46, v42, s64
    v_perm_b32 v124, v46, v42, s65
    v_perm_b32 v128, v47, v43, s64
    v_perm_b32 v132, v47, v43, s65
    v_perm_b32 v105, v52, v48, s64
    v_perm_b32 v109, v52, v48, s65
    v_perm_b32 v113, v53, v49, s64
    v_perm_b32 v117, v53, v49, s65
    v_perm_b32 v121, v54, v50, s64
    v_perm_b32 v125, v54, v50, s65
    v_perm_b32 v129, v55, v51, s64
    v_perm_b32 v133, v55, v51, s65
    v_perm_b32 v106, v60, v56, s64
    v_perm_b32 v110, v60, v56, s65
    v_perm_b32 v114, v61, v57, s64
    v_perm_b32 v118, v61, v57, s65
    v_perm_b32 v122, v62, v58, s64
    v_perm_b32 v126, v62, v58, s65
    v_perm_b32 v130, v63, v59, s64
    v_perm_b32 v134, v63, v59, s65
    v_perm_b32 v107, v68, v64, s64
    v_perm_b32 v111, v68, v64, s65
    v_perm_b32 v115, v69, v65, s64
    v_perm_b32 v119, v69, v65, s65
    v_perm_b32 v123, v70, v66, s64
    v_perm_b32 v127, v70, v66, s65
    v_perm_b32 v131, v71, v67, s64
    v_perm_b32 v135, v71, v67, s65
    v_xor_b32 v10, s99, v36
    v_xor_b32 v11, s78, v37
    v_xor_b32 v12, s99, v38
    v_xor_b32 v13, s78, v39
    v_or3_b32 v10, v10, v11, v12
    v_or_b32 v10, v10, v13
    v_cmp_ne_u32 vcc, 0, v10
    s_cmp_eq_u64 vcc, 0
    s_cselect_b32 s98, 1, 0
    s_waitcnt vmcnt(3)
    s_add_u32 s7, s4, 98304
    buffer_load_dwordx4 v[96:99], v28, s[56:59], s7 offen offset:512 nt
    s_waitcnt vmcnt(3)
    s_add_u32 s7, s4, 98304
    buffer_load_dwordx4 v[100:103], v28, s[56:59], s7 offen offset:768 nt
    s_cmp_eq_u32 s15, 3
    s_cbranch_scc1 Ltd_51
    s_cmp_ge_u32 s14, 4
    s_cselect_b32 s68, 1, 0
    s_cmp_lt_u32 s2, 244
    s_cselect_b32 s68, s68, 0
    s_cmp_eq_u32 s68, 1
    s_cbranch_scc1 Ltg_50
    s_mov_b32 s52, s24
    s_and_b32 s53, s25, 0xffff
    s_mov_b32 s54, 4194304
    s_mov_b32 s55, 0x20000
    s_lshl_b32 s13, s66, 2
    s_add_u32 s13, s13, s14
    s_mov_b32 s11, s13
    s_mov_b32 s10, 1
    s_cmp_lt_u32 s14, 4
    s_cbranch_scc1 Lw_53
    s_add_u32 s11, s66, 28
    s_sub_u32 s13, s66, 4
    s_lshl_b32 s13, s13, 3
    s_add_u32 s13, s13, 3
    s_lshr_b32 s10, s3, 2
    s_branch Lw_54
Lw_53:
    s_and_b32 s68, s13, 7
    s_cmp_lg_u32 s68, 3
    s_cbranch_scc1 Lw_54
    s_lshr_b32 s10, s3, 2
    s_xor_b32 s10, s10, 1
Lw_54:
    s_and_b32 s12, s13, 0x18
    s_add_u32 s12, s12, s3
    s_lshl_b32 s12, s12, 17
    s_and_b32 s68, s13, 7
    s_lshl_b32 s68, s68, 7
    s_add_u32 s12, s12, s68
    v_lshrrev_b32 v34, 3, v1
    v_lshlrev_b32 v34, 10, v34
    v_lshl_add_u32 v34, v4, 4, v34
    s_cmp_eq_u32 s10, 1
    s_cselect_b32 s54, s54, 0
    s_mov_b32 s48, s24
    s_and_b32 s49, s25, 0xffff
    s_mov_b32 s50, 0
    s_mov_b32 s51, 0x20000
    s_mov_b32 s50, s54
    s_add_u32 s13, s12, 65536
    s_mov_b32 s10, 8192
    s_branch Lte_52
Ltg_50:
    s_mov_b32 s52, s28
    s_and_b32 s53, s29, 0xffff
    s_mov_b32 s54, 1835008
    s_mov_b32 s55, 0x20000
    s_sub_u32 s13, s14, 4
    s_lshl_b32 s13, s13, 3
    s_add_u32 s13, s13, s66
    s_mul_i32 s12, s3, 229376
    s_lshl_b32 s68, s13, 7
    s_add_u32 s12, s12, s68
    v_lshrrev_b32 v34, 3, v1
    v_mul_u32_u24 v34, 3584, v34
    v_lshl_add_u32 v34, v4, 4, v34
    s_mov_b32 s48, s28
    s_and_b32 s49, s29, 0xffff
    s_mov_b32 s50, 1835008
    s_mov_b32 s51, 0x20000
    s_mov_b32 s52, s30
    s_and_b32 s53, s31, 0xffff
    s_mov_b32 s54, 1835008
    s_mov_b32 s55, 0x20000
    s_mov_b32 s13, s12
    s_mov_b32 s10, 28672
    s_branch Lte_52
Ltd_51:
    s_mov_b32 s48, s32
    s_and_b32 s49, s33, 0xffff
    s_mov_b32 s50, 1835008
    s_mov_b32 s51, 0x20000
    s_mov_b32 s52, s32
    s_and_b32 s53, s33, 0xffff
    s_mov_b32 s54, 1835008
    s_mov_b32 s55, 0x20000
    s_lshl_b32 s12, s66, 1
    s_add_u32 s12, s12, s14
    s_lshl_b32 s12, s12, 6
    s_lshl_b32 s68, s3, 18
    s_add_u32 s12, s12, s68
    s_add_u32 s13, s12, 131072
    s_mov_b32 s10, 16384
    v_lshrrev_b32 v34, 2, v1
    v_lshlrev_b32 v34, 10, v34
    v_and_b32 v10, 3, v1
    v_lshl_add_u32 v34, v10, 4, v34
Lte_52:
    s_waitcnt lgkmcnt(0)
    s_lshl_b32 s9, s8, 11
    s_add_u32 s9, s9, 393216
    s_cmp_lg_u32 s3, 0
    s_cbranch_scc1 Lqp_55
    buffer_load_dwordx4 v[232:235], v7, s[44:47], s9 offen offset:0 sc1
    buffer_load_dwordx4 v[236:239], v7, s[44:47], s9 offen offset:1024 sc1
Lqp_55:
    s_waitcnt vmcnt(3)
    s_mul_i32 s68, s10, 0
    s_add_u32 s68, s68, s12
    s_add_u32 m0, s6, 0
    s_nop 0
    buffer_load_dwordx4 v34, s[48:51], s68 offen nt lds
    s_waitcnt vmcnt(3)
    s_mul_i32 s68, s10, 1
    s_add_u32 s68, s68, s12
    s_add_u32 m0, s6, 1024
    s_nop 0
    buffer_load_dwordx4 v34, s[48:51], s68 offen nt lds
    s_waitcnt vmcnt(3)
    s_mul_i32 s68, s10, 2
    s_add_u32 s68, s68, s12
    s_add_u32 m0, s6, 2048
    s_nop 0
    buffer_load_dwordx4 v34, s[48:51], s68 offen nt lds
    s_waitcnt vmcnt(3)
    s_mul_i32 s68, s10, 3
    s_add_u32 s68, s68, s12
    s_add_u32 m0, s6, 3072
    s_nop 0
    buffer_load_dwordx4 v34, s[48:51], s68 offen nt lds
    s_cmp_lg_u32 s3, 0
    s_cbranch_scc1 Lq_56
    s_waitcnt vmcnt(4)
    v_min3_u32 v10, v233, v235, v237
    v_min_u32 v10, v10, v239
    v_max3_u32 v11, v233, v235, v237
    v_max_u32 v11, v11, v239
    v_xor_b32 v10, s78, v10
    v_xor_b32 v11, s78, v11
    v_or_b32 v10, v10, v11
    v_cmp_ne_u32 vcc, 0, v10
    s_cbranch_vccz Lq_57
    s_mov_b32 s79, 0
Lpoll_58:
    buffer_load_dwordx4 v[232:235], v7, s[44:47], s9 offen offset:0 sc1
    buffer_load_dwordx4 v[236:239], v7, s[44:47], s9 offen offset:1024 sc1
    s_waitcnt vmcnt(0)
    v_min3_u32 v10, v233, v235, v237
    v_min_u32 v10, v10, v239
    v_max3_u32 v11, v233, v235, v237
    v_max_u32 v11, v11, v239
    v_xor_b32 v10, s78, v10
    v_xor_b32 v11, s78, v11
    v_or_b32 v10, v10, v11
    v_cmp_ne_u32 vcc, 0, v10
    s_cbranch_vccz Ldone_59
    s_sleep 2
    s_add_u32 s79, s79, 1
    s_cmp_lt_u32 s79, 400000
    s_cbranch_scc1 Lpoll_58
Ldone_59:
Lq_57:
    ds_write2_b32 v27, v232, v234 offset0:0 offset1:1
    ds_write2_b32 v27, v236, v238 offset0:128 offset1:129
Lq_56:
    s_lshl_b32 s68, s3, 2
    v_add_u32 v16, s68, v33
    s_waitcnt lgkmcnt(0)
    s_barrier
    ds_read_b128 v[200:203], v26 offset:0
    ds_read_b128 v[204:207], v26 offset:64
    ds_read_b128 v[208:211], v26 offset:128
    ds_read_b128 v[212:215], v26 offset:192
    s_mul_i32 s68, s10, 4
    s_add_u32 s68, s68, s12
    s_add_u32 m0, s6, 4096
    s_nop 0
    buffer_load_dwordx4 v34, s[48:51], s68 offen nt lds
    s_mul_i32 s68, s10, 5
    s_add_u32 s68, s68, s12
    s_add_u32 m0, s6, 5120
    s_nop 0
    buffer_load_dwordx4 v34, s[48:51], s68 offen nt lds
    s_waitcnt lgkmcnt(3)
    v_mfma_f32_16x16x32_bf16 v[216:219], v[136:139], v[200:203], 0
    v_mfma_f32_16x16x32_bf16 v[220:223], v[152:155], v[200:203], 0
    v_mfma_f32_16x16x32_bf16 v[224:227], v[168:171], v[200:203], 0
    v_mfma_f32_16x16x32_bf16 v[228:231], v[184:187], v[200:203], 0
    s_waitcnt lgkmcnt(2)
    v_mfma_f32_16x16x32_bf16 v[216:219], v[140:143], v[204:207], v[216:219]
    v_mfma_f32_16x16x32_bf16 v[220:223], v[156:159], v[204:207], v[220:223]
    v_mfma_f32_16x16x32_bf16 v[224:227], v[172:175], v[204:207], v[224:227]
    v_mfma_f32_16x16x32_bf16 v[228:231], v[188:191], v[204:207], v[228:231]
    s_waitcnt lgkmcnt(1)
    v_mfma_f32_16x16x32_bf16 v[216:219], v[144:147], v[208:211], v[216:219]
    v_mfma_f32_16x16x32_bf16 v[220:223], v[160:163], v[208:211], v[220:223]
    v_mfma_f32_16x16x32_bf16 v[224:227], v[176:179], v[208:211], v[224:227]
    v_mfma_f32_16x16x32_bf16 v[228:231], v[192:195], v[208:211], v[228:231]
    s_waitcnt lgkmcnt(0)
    v_mfma_f32_16x16x32_bf16 v[216:219], v[148:151], v[212:215], v[216:219]
    v_mfma_f32_16x16x32_bf16 v[220:223], v[164:167], v[212:215], v[220:223]
    v_mfma_f32_16x16x32_bf16 v[224:227], v[180:183], v[212:215], v[224:227]
    v_mfma_f32_16x16x32_bf16 v[228:231], v[196:199], v[212:215], v[228:231]
    s_mul_i32 s68, s10, 6
    s_add_u32 s68, s68, s12
    s_add_u32 m0, s6, 6144
    s_nop 0
    buffer_load_dwordx4 v34, s[48:51], s68 offen nt lds
    s_mov_b32 exec_lo, 0xf000f0
    s_mov_b32 exec_hi, 0xf000f0
    v_mov_b32 v216, v220
    v_mov_b32 v217, v221
    v_mov_b32 v218, v222
    v_mov_b32 v219, v223
    s_mov_b32 exec_lo, 0xf000f00
    s_mov_b32 exec_hi, 0xf000f00
    v_mov_b32 v216, v224
    v_mov_b32 v217, v225
    v_mov_b32 v218, v226
    v_mov_b32 v219, v227
    s_mov_b32 exec_lo, 0xf000f000
    s_mov_b32 exec_hi, 0xf000f000
    v_mov_b32 v216, v228
    v_mov_b32 v217, v229
    v_mov_b32 v218, v230
    v_mov_b32 v219, v231
    s_mov_b64 exec, -1
    v_cvt_pk_bf16_f32 v216, 0, v216
    v_cvt_pk_bf16_f32 v217, 0, v217
    v_cvt_pk_bf16_f32 v218, 0, v218
    v_cvt_pk_bf16_f32 v219, 0, v219
    v_mul_f32 v216, 0x3db504f3, v216
    v_mul_f32 v217, 0x3db504f3, v217
    v_mul_f32 v218, 0x3db504f3, v218
    v_mul_f32 v219, 0x3db504f3, v219
    v_cvt_pk_bf16_f32 v216, 0, v216
    v_cvt_pk_bf16_f32 v217, 0, v217
    v_cvt_pk_bf16_f32 v218, 0, v218
    v_cvt_pk_bf16_f32 v219, 0, v219
    v_max_f32 v236, v216, v217
    v_max3_f32 v236, v236, v218, v219
    s_nop 1
    v_max_f32_dpp v236, v236, v236 row_ror:4 row_mask:0xf bank_mask:0xf
    s_nop 1
    v_max_f32_dpp v236, v236, v236 row_ror:8 row_mask:0xf bank_mask:0xf
    v_mov_b32 v14, v236
    s_nop 1
    v_permlane16_swap_b32 v236, v14
    v_max_f32 v236, v236, v14
    v_mov_b32 v14, v236
    s_nop 1
    v_permlane32_swap_b32 v236, v14
    v_max_f32 v236, v236, v14
    s_mov_b64 exec, 0xf
    ds_write_b32 v16, v236
    s_mov_b64 exec, -1
    v_mov_b32 v17, 0x3fb8aa3b
    v_mov_b32 v136, 0
    v_mov_b32 v137, 0
    v_mov_b32 v138, 0
    v_mov_b32 v139, 0
    v_mov_b32 v140, 0
    v_mov_b32 v141, 0
    v_mov_b32 v142, 0
    v_mov_b32 v143, 0
    v_mov_b32 v144, 0
    v_mov_b32 v145, 0
    v_mov_b32 v146, 0
    v_mov_b32 v147, 0
    v_mov_b32 v148, 0
    v_mov_b32 v149, 0
    v_mov_b32 v150, 0
    v_mov_b32 v151, 0
    v_mov_b32 v152, 0
    v_mov_b32 v153, 0
    v_mov_b32 v154, 0
    v_mov_b32 v155, 0
    v_mov_b32 v156, 0
    v_mov_b32 v157, 0
    v_mov_b32 v158, 0
    v_mov_b32 v159, 0
    v_mov_b32 v160, 0
    v_mov_b32 v161, 0
    v_mov_b32 v162, 0
    v_mov_b32 v163, 0
    v_mov_b32 v164, 0
    v_mov_b32 v165, 0
    v_mov_b32 v166, 0
    v_mov_b32 v167, 0
    s_waitcnt lgkmcnt(0)
    s_mul_i32 s68, s10, 7
    s_add_u32 s68, s68, s12
    s_add_u32 m0, s6, 7168
    s_nop 0
    buffer_load_dwordx4 v34, s[48:51], s68 offen nt lds
    s_barrier
    ds_read_b128 v[184:187], v33
    ds_read_b128 v[188:191], v33 offset:16
    s_waitcnt lgkmcnt(0)
    v_max3_f32 v236, v184, v185, v186
    v_max3_f32 v13, v187, v188, v189
    v_max3_f32 v236, v236, v190, v191
    v_max_f32 v236, v236, v13
    v_mul_f32 v236, v236, v17
    v_fma_f32 v216, v216, v17, -v236
    v_fma_f32 v217, v217, v17, -v236
    v_fma_f32 v218, v218, v17, -v236
    v_fma_f32 v219, v219, v17, -v236
    v_exp_f32 v216, v216
    v_exp_f32 v217, v217
    v_exp_f32 v218, v218
    v_exp_f32 v219, v219
    v_cvt_pk_bf16_f32 v220, v216, v217
    v_cvt_pk_bf16_f32 v221, v218, v219
    v_add_f32 v216, v216, v217
    v_add_f32 v218, v218, v219
    v_add_f32 v13, v216, v218
    v_mov_b32_dpp v136, v220 quad_perm:[0,1,2,3] row_mask:0xf bank_mask:0x1
    v_mov_b32_dpp v140, v220 row_ror:4 row_mask:0xf bank_mask:0x2
    v_mov_b32_dpp v144, v220 row_ror:8 row_mask:0xf bank_mask:0x4
    v_mov_b32_dpp v148, v220 row_ror:12 row_mask:0xf bank_mask:0x8
    v_mov_b32_dpp v137, v221 quad_perm:[0,1,2,3] row_mask:0xf bank_mask:0x1
    v_mov_b32_dpp v141, v221 row_ror:4 row_mask:0xf bank_mask:0x2
    v_mov_b32_dpp v145, v221 row_ror:8 row_mask:0xf bank_mask:0x4
    v_mov_b32_dpp v149, v221 row_ror:12 row_mask:0xf bank_mask:0x8
    v_mov_b32_dpp v138, v220 row_ror:12 row_mask:0xf bank_mask:0x1
    v_mov_b32_dpp v142, v220 quad_perm:[0,1,2,3] row_mask:0xf bank_mask:0x2
    v_mov_b32_dpp v146, v220 row_ror:4 row_mask:0xf bank_mask:0x4
    v_mov_b32_dpp v150, v220 row_ror:8 row_mask:0xf bank_mask:0x8
    v_mov_b32_dpp v139, v221 row_ror:12 row_mask:0xf bank_mask:0x1
    v_mov_b32_dpp v143, v221 quad_perm:[0,1,2,3] row_mask:0xf bank_mask:0x2
    v_mov_b32_dpp v147, v221 row_ror:4 row_mask:0xf bank_mask:0x4
    v_mov_b32_dpp v151, v221 row_ror:8 row_mask:0xf bank_mask:0x8
    v_mov_b32_dpp v152, v220 row_ror:8 row_mask:0xf bank_mask:0x1
    v_mov_b32_dpp v156, v220 row_ror:12 row_mask:0xf bank_mask:0x2
    v_mov_b32_dpp v160, v220 quad_perm:[0,1,2,3] row_mask:0xf bank_mask:0x4
    v_mov_b32_dpp v164, v220 row_ror:4 row_mask:0xf bank_mask:0x8
    v_mov_b32_dpp v153, v221 row_ror:8 row_mask:0xf bank_mask:0x1
    v_mov_b32_dpp v157, v221 row_ror:12 row_mask:0xf bank_mask:0x2
    v_mov_b32_dpp v161, v221 quad_perm:[0,1,2,3] row_mask:0xf bank_mask:0x4
    v_mov_b32_dpp v165, v221 row_ror:4 row_mask:0xf bank_mask:0x8
    v_mov_b32_dpp v154, v220 row_ror:4 row_mask:0xf bank_mask:0x1
    v_mov_b32_dpp v158, v220 row_ror:8 row_mask:0xf bank_mask:0x2
    v_mov_b32_dpp v162, v220 row_ror:12 row_mask:0xf bank_mask:0x4
    v_mov_b32_dpp v166, v220 quad_perm:[0,1,2,3] row_mask:0xf bank_mask:0x8
    v_mov_b32_dpp v155, v221 row_ror:4 row_mask:0xf bank_mask:0x1
    v_mov_b32_dpp v159, v221 row_ror:8 row_mask:0xf bank_mask:0x2
    v_mov_b32_dpp v163, v221 row_ror:12 row_mask:0xf bank_mask:0x4
    v_mov_b32_dpp v167, v221 quad_perm:[0,1,2,3] row_mask:0xf bank_mask:0x8
    v_add_f32_dpp v13, v13, v13 row_ror:4 row_mask:0xf bank_mask:0xf
    s_nop 1
    v_add_f32_dpp v13, v13, v13 row_ror:8 row_mask:0xf bank_mask:0xf
    v_mov_b32 v14, v13
    s_nop 1
    v_permlane16_swap_b32 v13, v14
    v_add_f32 v13, v13, v14
    v_mov_b32 v14, v13
    s_nop 1
    v_permlane32_swap_b32 v13, v14
    v_add_f32 v13, v13, v14
    s_mov_b64 exec, 0xf
    ds_write_b32 v16, v13 offset:128
    s_mov_b64 exec, -1
    v_mov_b32 v233, s78
    v_mov_b32 v235, s78
    v_mov_b32 v237, s78
    v_mov_b32 v239, s78
    s_and_b32 s68, s3, 3
    v_readlane_b32 s75, v236, s68
    s_lshl_b32 s68, s68, 5
    s_add_u32 s68, s68, 148608
    v_mov_b32 v33, s68
    v_mov_b32 v236, s75
    s_waitcnt vmcnt(8)
    v_perm_b32 v40, v76, v72, s64
    v_perm_b32 v44, v76, v72, s65
    v_perm_b32 v48, v77, v73, s64
    v_perm_b32 v52, v77, v73, s65
    v_perm_b32 v56, v78, v74, s64
    v_perm_b32 v60, v78, v74, s65
    v_perm_b32 v64, v79, v75, s64
    v_perm_b32 v68, v79, v75, s65
    v_perm_b32 v41, v84, v80, s64
    v_perm_b32 v45, v84, v80, s65
    v_perm_b32 v49, v85, v81, s64
    v_perm_b32 v53, v85, v81, s65
    v_perm_b32 v57, v86, v82, s64
    v_perm_b32 v61, v86, v82, s65
    v_perm_b32 v65, v87, v83, s64
    v_perm_b32 v69, v87, v83, s65
    v_perm_b32 v42, v92, v88, s64
    v_perm_b32 v46, v92, v88, s65
    v_perm_b32 v50, v93, v89, s64
    v_perm_b32 v54, v93, v89, s65
    v_perm_b32 v58, v94, v90, s64
    v_perm_b32 v62, v94, v90, s65
    v_perm_b32 v66, v95, v91, s64
    v_perm_b32 v70, v95, v91, s65
    v_perm_b32 v43, v100, v96, s64
    v_perm_b32 v47, v100, v96, s65
    v_perm_b32 v51, v101, v97, s64
    v_perm_b32 v55, v101, v97, s65
    v_perm_b32 v59, v102, v98, s64
    v_perm_b32 v63, v102, v98, s65
    v_perm_b32 v67, v103, v99, s64
    v_perm_b32 v71, v103, v99, s65
    s_mov_b32 s69, 0
L_J:
    s_and_b32 s68, s3, 3
    s_lshl_b32 s70, s8, 2
    s_add_u32 s70, s70, s68
    s_lshl_b32 s70, s70, 2
    s_lshl_b32 s73, s70, 10
    s_add_u32 s73, s73, 1048576
    s_lshl_b32 s74, s70, 4
    s_add_u32 s74, s74, 524288
    s_add_u32 s70, s70, s15
    s_lshl_b32 s71, s70, 4
    s_add_u32 s71, s71, 524288
    s_lshl_b32 s70, s70, 10
    s_add_u32 s70, s70, 1048576
    s_lshl_b32 s72, s8, 10
    s_lshl_b32 s68, s3, 8
    s_add_u32 s72, s72, s68
    s_add_u32 s72, s72, 65536
    v_mfma_f32_16x16x32_bf16 v[192:195], v[136:139], v[104:107], 0
    v_mfma_f32_16x16x32_bf16 v[196:199], v[136:139], v[120:123], 0
    v_mfma_f32_16x16x32_bf16 v[192:195], v[140:143], v[108:111], v[192:195]
    v_mfma_f32_16x16x32_bf16 v[196:199], v[140:143], v[124:127], v[196:199]
    v_mfma_f32_16x16x32_bf16 v[192:195], v[144:147], v[112:115], v[192:195]
    v_mfma_f32_16x16x32_bf16 v[196:199], v[144:147], v[128:131], v[196:199]
    v_mfma_f32_16x16x32_bf16 v[192:195], v[148:151], v[116:119], v[192:195]
    v_mfma_f32_16x16x32_bf16 v[196:199], v[148:151], v[132:135], v[196:199]
    s_cmp_eq_u32 s69, 0
    s_cbranch_scc1 Ltr_60
    s_waitcnt vmcnt(6)
    v_perm_b32 v40, v76, v72, s64
    v_perm_b32 v44, v76, v72, s65
    v_perm_b32 v48, v77, v73, s64
    v_perm_b32 v52, v77, v73, s65
    v_perm_b32 v56, v78, v74, s64
    v_perm_b32 v60, v78, v74, s65
    v_perm_b32 v64, v79, v75, s64
    v_perm_b32 v68, v79, v75, s65
    s_waitcnt vmcnt(4)
    v_perm_b32 v41, v84, v80, s64
    v_perm_b32 v45, v84, v80, s65
    v_perm_b32 v49, v85, v81, s64
    v_perm_b32 v53, v85, v81, s65
    v_perm_b32 v57, v86, v82, s64
    v_perm_b32 v61, v86, v82, s65
    v_perm_b32 v65, v87, v83, s64
    v_perm_b32 v69, v87, v83, s65
    s_waitcnt vmcnt(2)
    v_perm_b32 v42, v92, v88, s64
    v_perm_b32 v46, v92, v88, s65
    v_perm_b32 v50, v93, v89, s64
    v_perm_b32 v54, v93, v89, s65
    v_perm_b32 v58, v94, v90, s64
    v_perm_b32 v62, v94, v90, s65
    v_perm_b32 v66, v95, v91, s64
    v_perm_b32 v70, v95, v91, s65
    s_waitcnt vmcnt(0)
    s_cmp_lg_u32 s15, 0
    s_cbranch_scc1 Lni_61
    s_cmp_ge_u32 s3, 4
    s_cbranch_scc1 Lni_61
    buffer_load_dwordx4 v[168:171], v7, s[44:47], s73 offen offset:1024 sc1
    buffer_load_dwordx4 v[200:203], off, s[44:47], s74 offset:16 sc1
    buffer_load_dwordx4 v[172:175], v7, s[44:47], s73 offen offset:2048 sc1
    buffer_load_dwordx4 v[204:207], off, s[44:47], s74 offset:32 sc1
    buffer_load_dwordx4 v[176:179], v7, s[44:47], s73 offen offset:3072 sc1
    buffer_load_dwordx4 v[208:211], off, s[44:47], s74 offset:48 sc1
Lni_61:
    v_perm_b32 v43, v100, v96, s64
    v_perm_b32 v47, v100, v96, s65
    v_perm_b32 v51, v101, v97, s64
    v_perm_b32 v55, v101, v97, s65
    v_perm_b32 v59, v102, v98, s64
    v_perm_b32 v63, v102, v98, s65
    v_perm_b32 v67, v103, v99, s64
    v_perm_b32 v71, v103, v99, s65
Ltr_60:
    v_mfma_f32_16x16x32_bf16 v[192:195], v[152:155], v[40:43], v[192:195]
    v_mfma_f32_16x16x32_bf16 v[196:199], v[152:155], v[56:59], v[196:199]
    v_mfma_f32_16x16x32_bf16 v[192:195], v[156:159], v[44:47], v[192:195]
    v_mfma_f32_16x16x32_bf16 v[196:199], v[156:159], v[60:63], v[196:199]
    v_mfma_f32_16x16x32_bf16 v[192:195], v[160:163], v[48:51], v[192:195]
    v_mfma_f32_16x16x32_bf16 v[196:199], v[160:163], v[64:67], v[196:199]
    v_mfma_f32_16x16x32_bf16 v[192:195], v[164:167], v[52:55], v[192:195]
    v_mfma_f32_16x16x32_bf16 v[196:199], v[164:167], v[68:71], v[196:199]
    s_nop 6
    ds_write_b128 v29, v[192:195]
    ds_write_b128 v30, v[196:199]
    s_waitcnt lgkmcnt(0)
    s_barrier
    s_cmp_ge_u32 s3, 4
    s_cbranch_scc1 Lsdone_62
    ds_read_b128 v[184:187], v33
    ds_read_b128 v[188:191], v33 offset:16
    ds_read2st64_b32 v[216:217], v31 offset0:0 offset1:8
    ds_read2st64_b32 v[218:219], v31 offset0:16 offset1:24
    ds_read2st64_b32 v[220:221], v31 offset0:32 offset1:40
    ds_read2st64_b32 v[222:223], v31 offset0:48 offset1:56
    ds_read2st64_b32 v[224:225], v32 offset0:0 offset1:8
    ds_read2st64_b32 v[226:227], v32 offset0:16 offset1:24
    ds_read2st64_b32 v[228:229], v32 offset0:32 offset1:40
    ds_read2st64_b32 v[230:231], v32 offset0:48 offset1:56
    s_waitcnt lgkmcnt(8)
    v_pk_add_f32 v[184:185], v[184:185], v[186:187]
    v_pk_add_f32 v[188:189], v[188:189], v[190:191]
    v_pk_add_f32 v[184:185], v[184:185], v[188:189]
    v_add_f32 v238, v184, v185
    s_waitcnt lgkmcnt(4)
    v_pk_add_f32 v[216:217], v[216:217], v[218:219]
    v_pk_add_f32 v[220:221], v[220:221], v[222:223]
    v_pk_add_f32 v[216:217], v[216:217], v[220:221]
    v_add_f32 v232, v216, v217
    s_waitcnt lgkmcnt(0)
    v_pk_add_f32 v[224:225], v[224:225], v[226:227]
    v_pk_add_f32 v[228:229], v[228:229], v[230:231]
    v_pk_add_f32 v[224:225], v[224:225], v[228:229]
    v_add_f32 v234, v224, v225
    s_cmp_eq_u32 s15, 0
    s_cbranch_scc1 Lown_63
    s_cmp_eq_u32 s98, 1
    s_cbranch_scc1 Lst_64
    buffer_store_dwordx4 v[232:235], v7, s[44:47], s70 offen sc1
    s_branch Lse_65
Lst_64:
    buffer_store_dwordx4 v[232:235], v7, s[44:47], s70 offen
Lse_65:
    s_mov_b64 exec, 1
    s_cmp_eq_u32 s98, 1
    s_cbranch_scc1 Lst_66
    buffer_store_dwordx4 v[236:239], off, s[44:47], s71 sc1
    s_branch Lse_67
Lst_66:
    buffer_store_dwordx4 v[236:239], off, s[44:47], s71
Lse_67:
    s_mov_b64 exec, -1
    s_branch Lsdone_62
Lown_63:
    s_waitcnt vmcnt(0)
    v_min3_u32 v10, v169, v171, v173
    v_min3_u32 v10, v10, v175, v177
    v_min3_u32 v10, v10, v179, v201
    v_min3_u32 v10, v10, v203, v205
    v_min3_u32 v10, v10, v207, v209
    v_min_u32 v10, v10, v211
    v_max3_u32 v11, v169, v171, v173
    v_max3_u32 v11, v11, v175, v177
    v_max3_u32 v11, v11, v179, v201
    v_max3_u32 v11, v11, v203, v205
    v_max3_u32 v11, v11, v207, v209
    v_max_u32 v11, v11, v211
    v_xor_b32 v10, s78, v10
    v_xor_b32 v11, s78, v11
    v_or_b32 v10, v10, v11
    v_cmp_ne_u32 vcc, 0, v10
    s_cbranch_vccz Lio_68
    s_mov_b32 s79, 0
Lpoll_69:
    buffer_load_dwordx4 v[168:171], v7, s[44:47], s73 offen offset:1024 sc1
    buffer_load_dwordx4 v[200:203], off, s[44:47], s74 offset:16 sc1
    buffer_load_dwordx4 v[172:175], v7, s[44:47], s73 offen offset:2048 sc1
    buffer_load_dwordx4 v[204:207], off, s[44:47], s74 offset:32 sc1
    buffer_load_dwordx4 v[176:179], v7, s[44:47], s73 offen offset:3072 sc1
    buffer_load_dwordx4 v[208:211], off, s[44:47], s74 offset:48 sc1
    s_waitcnt vmcnt(0)
    v_min3_u32 v10, v169, v171, v173
    v_min3_u32 v10, v10, v175, v177
    v_min3_u32 v10, v10, v179, v201
    v_min3_u32 v10, v10, v203, v205
    v_min3_u32 v10, v10, v207, v209
    v_min_u32 v10, v10, v211
    v_max3_u32 v11, v169, v171, v173
    v_max3_u32 v11, v11, v175, v177
    v_max3_u32 v11, v11, v179, v201
    v_max3_u32 v11, v11, v203, v205
    v_max3_u32 v11, v11, v207, v209
    v_max_u32 v11, v11, v211
    v_xor_b32 v10, s78, v10
    v_xor_b32 v11, s78, v11
    v_or_b32 v10, v10, v11
    v_cmp_ne_u32 vcc, 0, v10
    s_cbranch_vccz Ldone_70
    s_sleep 1
    s_add_u32 s79, s79, 1
    s_cmp_lt_u32 s79, 400000
    s_cbranch_scc1 Lpoll_69
Ldone_70:
Lio_68:
    v_max3_f32 v12, v200, v204, v208
    v_max_f32 v12, v12, v236
    v_sub_f32 v200, v200, v12
    v_sub_f32 v204, v204, v12
    v_sub_f32 v208, v208, v12
    v_sub_f32 v236, v236, v12
    v_exp_f32 v200, v200
    v_exp_f32 v204, v204
    v_exp_f32 v208, v208
    v_exp_f32 v236, v236
    s_nop 0
    v_mul_f32 v238, v238, v236
    v_mul_f32 v232, v232, v236
    v_mul_f32 v234, v234, v236
    v_fmac_f32 v238, v200, v202
    v_fmac_f32 v232, v200, v168
    v_fmac_f32 v234, v200, v170
    v_fmac_f32 v238, v204, v206
    v_fmac_f32 v232, v204, v172
    v_fmac_f32 v234, v204, v174
    v_fmac_f32 v238, v208, v210
    v_fmac_f32 v232, v208, v176
    v_fmac_f32 v234, v208, v178
    v_rcp_f32 v238, v238
    v_lshlrev_b32 v14, 2, v1
    v_mul_f32 v232, v232, v238
    v_mul_f32 v234, v234, v238
    v_cvt_pk_bf16_f32 v232, v232, v234
    v_min_u32 v232, -2, v232
    buffer_store_dword v232, v14, s[44:47], s72 offen sc1
Lsdone_62:
    s_cmp_lg_u32 s5, 2
    s_cbranch_scc1 L_FIN
    s_cmp_eq_u32 s15, 3
    s_cbranch_scc1 L_DN
    s_cmp_lt_u32 s14, 4
    s_cbranch_scc1 L_WO
    s_cmp_lt_u32 s2, 244
    s_cbranch_scc1 L_GU
    s_branch L_WO
L_FIN:
    s_endpgm
L_WO:
    s_lshl_b32 s70, s3, 14
    s_cmp_eq_u32 s15, 3
    s_cbranch_scc1 Ltd_72
    s_cmp_ge_u32 s14, 4
    s_cselect_b32 s68, 1, 0
    s_cmp_lt_u32 s2, 244
    s_cselect_b32 s68, s68, 0
    s_cmp_eq_u32 s68, 1
    s_cbranch_scc1 Ltg_71
    s_mov_b32 s52, s24
    s_and_b32 s53, s25, 0xffff
    s_mov_b32 s54, 4194304
    s_mov_b32 s55, 0x20000
    s_lshl_b32 s13, s66, 2
    s_add_u32 s13, s13, s14
    s_mov_b32 s11, s13
    s_mov_b32 s10, 1
    s_cmp_lt_u32 s14, 4
    s_cbranch_scc1 Lw_74
    s_add_u32 s11, s66, 28
    s_sub_u32 s13, s66, 4
    s_lshl_b32 s13, s13, 3
    s_add_u32 s13, s13, 3
    s_lshr_b32 s10, s3, 2
    s_branch Lw_75
Lw_74:
    s_and_b32 s68, s13, 7
    s_cmp_lg_u32 s68, 3
    s_cbranch_scc1 Lw_75
    s_lshr_b32 s10, s3, 2
    s_xor_b32 s10, s10, 1
Lw_75:
    s_and_b32 s12, s13, 0x18
    s_add_u32 s12, s12, s3
    s_lshl_b32 s12, s12, 17
    s_and_b32 s68, s13, 7
    s_lshl_b32 s68, s68, 7
    s_add_u32 s12, s12, s68
    v_lshrrev_b32 v180, 3, v1
    v_lshlrev_b32 v180, 10, v180
    v_lshl_add_u32 v180, v4, 4, v180
    s_cmp_eq_u32 s10, 1
    s_cselect_b32 s54, s54, 0
    s_mov_b32 s48, s24
    s_and_b32 s49, s25, 0xffff
    s_mov_b32 s50, 0
    s_mov_b32 s51, 0x20000
    s_mov_b32 s50, s54
    s_add_u32 s13, s12, 65536
    s_mov_b32 s10, 8192
    s_branch Lte_73
Ltg_71:
    s_mov_b32 s52, s28
    s_and_b32 s53, s29, 0xffff
    s_mov_b32 s54, 1835008
    s_mov_b32 s55, 0x20000
    s_sub_u32 s13, s14, 4
    s_lshl_b32 s13, s13, 3
    s_add_u32 s13, s13, s66
    s_mul_i32 s12, s3, 229376
    s_lshl_b32 s68, s13, 7
    s_add_u32 s12, s12, s68
    v_lshrrev_b32 v180, 3, v1
    v_mul_u32_u24 v180, 3584, v180
    v_lshl_add_u32 v180, v4, 4, v180
    s_mov_b32 s48, s28
    s_and_b32 s49, s29, 0xffff
    s_mov_b32 s50, 1835008
    s_mov_b32 s51, 0x20000
    s_mov_b32 s52, s30
    s_and_b32 s53, s31, 0xffff
    s_mov_b32 s54, 1835008
    s_mov_b32 s55, 0x20000
    s_mov_b32 s13, s12
    s_mov_b32 s10, 28672
    s_branch Lte_73
Ltd_72:
    s_mov_b32 s48, s32
    s_and_b32 s49, s33, 0xffff
    s_mov_b32 s50, 1835008
    s_mov_b32 s51, 0x20000
    s_mov_b32 s52, s32
    s_and_b32 s53, s33, 0xffff
    s_mov_b32 s54, 1835008
    s_mov_b32 s55, 0x20000
    s_lshl_b32 s12, s66, 1
    s_add_u32 s12, s12, s14
    s_lshl_b32 s12, s12, 6
    s_lshl_b32 s68, s3, 18
    s_add_u32 s12, s12, s68
    s_add_u32 s13, s12, 131072
    s_mov_b32 s10, 16384
    v_lshrrev_b32 v180, 2, v1
    v_lshlrev_b32 v180, 10, v180
    v_and_b32 v10, 3, v1
    v_lshl_add_u32 v180, v10, 4, v180
Lte_73:
    s_waitcnt vmcnt(3)
    s_mul_i32 s68, s10, 0
    s_add_u32 s68, s68, s13
    s_add_u32 m0, s70, 8192
    s_nop 0
    buffer_load_dwordx4 v180, s[52:55], s68 offen nt lds
    s_waitcnt vmcnt(3)
    s_mul_i32 s68, s10, 1
    s_add_u32 s68, s68, s13
    s_add_u32 m0, s70, 9216
    s_nop 0
    buffer_load_dwordx4 v180, s[52:55], s68 offen nt lds
    s_waitcnt vmcnt(3)
    s_mul_i32 s68, s10, 2
    s_add_u32 s68, s68, s13
    s_add_u32 m0, s70, 10240
    s_nop 0
    buffer_load_dwordx4 v180, s[52:55], s68 offen nt lds
    s_waitcnt vmcnt(3)
    s_mul_i32 s68, s10, 3
    s_add_u32 s68, s68, s13
    s_add_u32 m0, s70, 11264
    s_nop 0
    buffer_load_dwordx4 v180, s[52:55], s68 offen nt lds
    s_waitcnt vmcnt(3)
    s_mul_i32 s68, s10, 4
    s_add_u32 s68, s68, s13
    s_add_u32 m0, s70, 12288
    s_nop 0
    buffer_load_dwordx4 v180, s[52:55], s68 offen nt lds
    s_waitcnt vmcnt(3)
    s_mul_i32 s68, s10, 5
    s_add_u32 s68, s68, s13
    s_add_u32 m0, s70, 13312
    s_nop 0
    buffer_load_dwordx4 v180, s[52:55], s68 offen nt lds
    s_waitcnt vmcnt(3)
    s_mul_i32 s68, s10, 6
    s_add_u32 s68, s68, s13
    s_add_u32 m0, s70, 14336
    s_nop 0
    buffer_load_dwordx4 v180, s[52:55], s68 offen nt lds
    s_waitcnt vmcnt(3)
    s_mul_i32 s68, s10, 7
    s_add_u32 s68, s68, s13
    s_add_u32 m0, s70, 15360
    s_nop 0
    buffer_load_dwordx4 v180, s[52:55], s68 offen nt lds
    s_mov_b32 s52, s24
    s_and_b32 s53, s25, 0xffff
    s_mov_b32 s54, 4194304
    s_mov_b32 s55, 0x20000
    s_lshl_b32 s13, s66, 2
    s_add_u32 s13, s13, s14
    s_mov_b32 s11, s13
    s_mov_b32 s10, 1
    s_cmp_lt_u32 s14, 4
    s_cbranch_scc1 Lw_76
    s_add_u32 s11, s66, 28
    s_sub_u32 s13, s66, 4
    s_lshl_b32 s13, s13, 3
    s_add_u32 s13, s13, 3
    s_lshr_b32 s10, s3, 2
    s_branch Lw_77
Lw_76:
    s_and_b32 s68, s13, 7
    s_cmp_lg_u32 s68, 3
    s_cbranch_scc1 Lw_77
    s_lshr_b32 s10, s3, 2
    s_xor_b32 s10, s10, 1
Lw_77:
    s_and_b32 s12, s13, 0x18
    s_add_u32 s12, s12, s3
    s_lshl_b32 s12, s12, 17
    s_and_b32 s68, s13, 7
    s_lshl_b32 s68, s68, 7
    s_add_u32 s12, s12, s68
    v_lshrrev_b32 v180, 3, v1
    v_lshlrev_b32 v180, 10, v180
    v_lshl_add_u32 v180, v4, 4, v180
    s_lshl_b32 s69, s11, 10
    s_add_u32 s69, s69, 131072
    s_and_b32 s71, s13, 0x18
    s_add_u32 s71, s71, s3
    s_lshl_b32 s71, s71, 8
    s_add_u32 s71, s71, 65536
    v_lshlrev_b32 v181, 13, v4
    v_lshl_add_u32 v181, v5, 1, v181
    v_and_b32 v10, 15, v1
    v_and_b32 v11, 1, v2
    v_xor_b32 v10, v10, v11
    s_mul_i32 s68, s3, 2048
    v_xor_b32 v12, 0, v10
    v_lshl_add_u32 v12, v11, 4, v12
    v_lshlrev_b32 v12, 4, v12
    v_add_u32 v12, 0, v12
    v_add_u32 v182, s68, v12
    v_xor_b32 v12, 2, v10
    v_lshl_add_u32 v12, v11, 4, v12
    v_lshlrev_b32 v12, 4, v12
    v_add_u32 v12, 512, v12
    v_add_u32 v183, s68, v12
    v_xor_b32 v12, 4, v10
    v_lshl_add_u32 v12, v11, 4, v12
    v_lshlrev_b32 v12, 4, v12
    v_add_u32 v12, 1024, v12
    v_add_u32 v184, s68, v12
    v_xor_b32 v12, 6, v10
    v_lshl_add_u32 v12, v11, 4, v12
    v_lshlrev_b32 v12, 4, v12
    v_add_u32 v12, 1536, v12
    v_add_u32 v185, s68, v12
    v_bfe_u32 v10, v1, 3, 2
    v_lshrrev_b32 v12, 5, v1
    v_bfe_u32 v11, v1, 2, 1
    s_lshl_b32 s68, s3, 1
    v_add_u32 v12, s68, v12
    v_lshl_add_u32 v13, v10, 1, v11
    v_xor_b32 v12, v12, v13
    v_lshl_add_u32 v12, v11, 4, v12
    v_mul_u32_u24 v10, 32, v10
    v_add_u32 v12, v12, v10
    v_and_b32 v11, 3, v1
    v_lshlrev_b32 v11, 2, v11
    v_lshl_add_u32 v186, v12, 4, v11
    s_and_b32 s68, s3, 3
    s_lshl_b32 s68, s68, 8
    s_add_u32 s69, s69, s68
    s_lshr_b32 s68, s3, 2
    s_lshl_b32 s68, s68, 7
    s_add_u32 s69, s69, s68
    v_lshlrev_b32 v187, 4, v4
    v_lshl_add_u32 v187, v2, 2, v187
    v_and_b32 v10, 15, v1
    v_lshlrev_b32 v10, 3, v10
    v_lshl_add_u32 v10, v2, 10, v10
    v_add_u32 v188, s70, v10
    v_mov_b32 v164, 0
    v_mov_b32 v165, 0
    v_mov_b32 v166, 0
    v_mov_b32 v167, 0
    v_mov_b32 v168, 0
    v_mov_b32 v169, 0
    v_mov_b32 v170, 0
    v_mov_b32 v171, 0
    v_mov_b32 v172, 0
    v_mov_b32 v173, 0
    v_mov_b32 v174, 0
    v_mov_b32 v175, 0
    v_mov_b32 v176, 0
    v_mov_b32 v177, 0
    v_mov_b32 v178, 0
    v_mov_b32 v179, 0
    s_cmp_eq_u32 s10, 0
    s_cbranch_scc1 Lidle_78
    s_waitcnt vmcnt(12)
    ds_read_b64 v[20:21], v188 offset:0
    ds_read_b64 v[22:23], v188 offset:128
    ds_read_b64 v[24:25], v188 offset:256
    ds_read_b64 v[26:27], v188 offset:384
    ds_read_b64 v[28:29], v188 offset:512
    ds_read_b64 v[30:31], v188 offset:640
    ds_read_b64 v[32:33], v188 offset:768
    ds_read_b64 v[34:35], v188 offset:896
    s_waitcnt lgkmcnt(0)
    v_perm_b32 v84, v22, v20, s64
    v_perm_b32 v88, v22, v20, s65
    v_perm_b32 v92, v23, v21, s64
    v_perm_b32 v96, v23, v21, s65
    v_perm_b32 v85, v26, v24, s64
    v_perm_b32 v89, v26, v24, s65
    v_perm_b32 v93, v27, v25, s64
    v_perm_b32 v97, v27, v25, s65
    v_perm_b32 v86, v30, v28, s64
    v_perm_b32 v90, v30, v28, s65
    v_perm_b32 v94, v31, v29, s64
    v_perm_b32 v98, v31, v29, s65
    v_perm_b32 v87, v34, v32, s64
    v_perm_b32 v91, v34, v32, s65
    v_perm_b32 v95, v35, v33, s64
    v_perm_b32 v99, v35, v33, s65
    s_waitcnt vmcnt(8)
    ds_read_b64 v[36:37], v188 offset:4096
    ds_read_b64 v[38:39], v188 offset:4224
    ds_read_b64 v[40:41], v188 offset:4352
    ds_read_b64 v[42:43], v188 offset:4480
    ds_read_b64 v[44:45], v188 offset:4608
    ds_read_b64 v[46:47], v188 offset:4736
    ds_read_b64 v[48:49], v188 offset:4864
    ds_read_b64 v[50:51], v188 offset:4992
    s_waitcnt lgkmcnt(0)
    v_perm_b32 v100, v38, v36, s64
    v_perm_b32 v104, v38, v36, s65
    v_perm_b32 v108, v39, v37, s64
    v_perm_b32 v112, v39, v37, s65
    v_perm_b32 v101, v42, v40, s64
    v_perm_b32 v105, v42, v40, s65
    v_perm_b32 v109, v43, v41, s64
    v_perm_b32 v113, v43, v41, s65
    v_perm_b32 v102, v46, v44, s64
    v_perm_b32 v106, v46, v44, s65
    v_perm_b32 v110, v47, v45, s64
    v_perm_b32 v114, v47, v45, s65
    v_perm_b32 v103, v50, v48, s64
    v_perm_b32 v107, v50, v48, s65
    v_perm_b32 v111, v51, v49, s64
    v_perm_b32 v115, v51, v49, s65
    s_waitcnt vmcnt(4)
    ds_read_b64 v[52:53], v188 offset:8192
    ds_read_b64 v[54:55], v188 offset:8320
    ds_read_b64 v[56:57], v188 offset:8448
    ds_read_b64 v[58:59], v188 offset:8576
    ds_read_b64 v[60:61], v188 offset:8704
    ds_read_b64 v[62:63], v188 offset:8832
    ds_read_b64 v[64:65], v188 offset:8960
    ds_read_b64 v[66:67], v188 offset:9088
    s_waitcnt lgkmcnt(0)
    v_perm_b32 v116, v54, v52, s64
    v_perm_b32 v120, v54, v52, s65
    v_perm_b32 v124, v55, v53, s64
    v_perm_b32 v128, v55, v53, s65
    v_perm_b32 v117, v58, v56, s64
    v_perm_b32 v121, v58, v56, s65
    v_perm_b32 v125, v59, v57, s64
    v_perm_b32 v129, v59, v57, s65
    v_perm_b32 v118, v62, v60, s64
    v_perm_b32 v122, v62, v60, s65
    v_perm_b32 v126, v63, v61, s64
    v_perm_b32 v130, v63, v61, s65
    v_perm_b32 v119, v66, v64, s64
    v_perm_b32 v123, v66, v64, s65
    v_perm_b32 v127, v67, v65, s64
    v_perm_b32 v131, v67, v65, s65
    s_waitcnt vmcnt(0)
    ds_read_b64 v[68:69], v188 offset:12288
    ds_read_b64 v[70:71], v188 offset:12416
    ds_read_b64 v[72:73], v188 offset:12544
    ds_read_b64 v[74:75], v188 offset:12672
    ds_read_b64 v[76:77], v188 offset:12800
    ds_read_b64 v[78:79], v188 offset:12928
    ds_read_b64 v[80:81], v188 offset:13056
    ds_read_b64 v[82:83], v188 offset:13184
    s_waitcnt lgkmcnt(0)
    v_perm_b32 v132, v70, v68, s64
    v_perm_b32 v136, v70, v68, s65
    v_perm_b32 v140, v71, v69, s64
    v_perm_b32 v144, v71, v69, s65
    v_perm_b32 v133, v74, v72, s64
    v_perm_b32 v137, v74, v72, s65
    v_perm_b32 v141, v75, v73, s64
    v_perm_b32 v145, v75, v73, s65
    v_perm_b32 v134, v78, v76, s64
    v_perm_b32 v138, v78, v76, s65
    v_perm_b32 v142, v79, v77, s64
    v_perm_b32 v146, v79, v77, s65
    v_perm_b32 v135, v82, v80, s64
    v_perm_b32 v139, v82, v80, s65
    v_perm_b32 v143, v83, v81, s64
    v_perm_b32 v147, v83, v81, s65
Lidle_78:
    s_barrier
    s_cmp_eq_u32 s10, 0
    s_cbranch_scc1 Lidle_79
    s_mov_b32 s79, 0
Lpoll_80:
    buffer_load_dwordx4 v[148:151], v181, s[44:47], s71 offen offset:0 sc1
    buffer_load_dwordx4 v[156:159], v181, s[44:47], s71 offen offset:128 sc1
    s_waitcnt vmcnt(0)
    v_mfma_f32_16x16x32_bf16 v[164:167], v[148:151], v[84:87], 0
    v_mfma_f32_16x16x32_bf16 v[168:171], v[148:151], v[88:91], 0
    v_mfma_f32_16x16x32_bf16 v[172:175], v[148:151], v[92:95], 0
    v_mfma_f32_16x16x32_bf16 v[176:179], v[148:151], v[96:99], 0
    v_mov_b32_dpp v152, v148 row_ror:8 row_mask:0xf bank_mask:0xf
    v_mov_b32_dpp v153, v149 row_ror:8 row_mask:0xf bank_mask:0xf
    v_mov_b32_dpp v154, v150 row_ror:8 row_mask:0xf bank_mask:0xf
    v_mov_b32_dpp v155, v151 row_ror:8 row_mask:0xf bank_mask:0xf
    v_mov_b32_dpp v160, v156 row_ror:8 row_mask:0xf bank_mask:0xf
    v_mov_b32_dpp v161, v157 row_ror:8 row_mask:0xf bank_mask:0xf
    v_mov_b32_dpp v162, v158 row_ror:8 row_mask:0xf bank_mask:0xf
    v_mov_b32_dpp v163, v159 row_ror:8 row_mask:0xf bank_mask:0xf
    v_mfma_f32_16x16x32_bf16 v[164:167], v[156:159], v[116:119], v[164:167]
    v_mfma_f32_16x16x32_bf16 v[168:171], v[156:159], v[120:123], v[168:171]
    v_mfma_f32_16x16x32_bf16 v[172:175], v[156:159], v[124:127], v[172:175]
    v_mfma_f32_16x16x32_bf16 v[176:179], v[156:159], v[128:131], v[176:179]
    v_max3_u32 v10, v148, v149, v150
    v_max3_u32 v10, v10, v151, v156
    v_max3_u32 v10, v10, v157, v158
    v_max_u32 v10, v10, v159
    v_cmp_eq_u32 vcc, -1, v10
    s_cbranch_vccz Ldone_81
    s_sleep 1
    s_add_u32 s79, s79, 1
    s_cmp_lt_u32 s79, 400000
    s_cbranch_scc1 Lpoll_80
Ldone_81:
    v_mfma_f32_16x16x32_bf16 v[164:167], v[152:155], v[100:103], v[164:167]
    v_mfma_f32_16x16x32_bf16 v[168:171], v[152:155], v[104:107], v[168:171]
    v_mfma_f32_16x16x32_bf16 v[172:175], v[152:155], v[108:111], v[172:175]
    v_mfma_f32_16x16x32_bf16 v[176:179], v[152:155], v[112:115], v[176:179]
    v_mfma_f32_16x16x32_bf16 v[164:167], v[160:163], v[132:135], v[164:167]
    v_mfma_f32_16x16x32_bf16 v[168:171], v[160:163], v[136:139], v[168:171]
    v_mfma_f32_16x16x32_bf16 v[172:175], v[160:163], v[140:143], v[172:175]
    v_mfma_f32_16x16x32_bf16 v[176:179], v[160:163], v[144:147], v[176:179]
Lidle_79:
    s_mov_b32 exec_lo, 0xffffffff
    s_mov_b32 exec_hi, 0x0
    s_nop 2
    ds_write_b128 v182, v[164:167]
    ds_write_b128 v183, v[168:171]
    ds_write_b128 v184, v[172:175]
    ds_write_b128 v185, v[176:179]
    s_mov_b64 exec, -1
    s_waitcnt lgkmcnt(0)
    s_barrier
    ds_read2st64_b32 v[20:21], v186 offset0:0 offset1:8
    ds_read2st64_b32 v[22:23], v186 offset0:16 offset1:24
    ds_read2st64_b32 v[24:25], v186 offset0:32 offset1:40
    ds_read2st64_b32 v[26:27], v186 offset0:48 offset1:56
    s_waitcnt lgkmcnt(2)
    v_pk_add_f32 v[20:21], v[20:21], v[22:23]
    s_waitcnt lgkmcnt(1)
    v_pk_add_f32 v[20:21], v[20:21], v[24:25]
    s_waitcnt lgkmcnt(0)
    v_pk_add_f32 v[20:21], v[20:21], v[26:27]
    v_add_f32 v10, v20, v21
    s_nop 1
    v_mov_b32_dpp v11, v10 row_ror:8 row_mask:0xf bank_mask:0xf
    v_cvt_pk_bf16_f32 v10, v10, v11
    s_mov_b32 exec_lo, 0xff00ff
    s_mov_b32 exec_hi, 0xff00ff
    v_min_u32 v10, -2, v10
    buffer_store_dword v10, v187, s[44:47], s69 offen sc1
    s_endpgm
L_DN:
    s_lshl_b32 s69, s66, 1
    s_add_u32 s69, s69, s14
    s_mov_b32 s60, s16
    s_and_b32 s61, s17, 0xffff
    s_mov_b32 s62, 8192
    s_mov_b32 s63, 0x20000
    s_mov_b32 s56, s38
    s_and_b32 s57, s39, 0xffff
    s_mov_b32 s58, 8192
    s_mov_b32 s59, 0x20000
    s_lshl_b32 s68, s69, 5
    s_lshl_b32 s4, s3, 3
    s_add_u32 s68, s68, s4
    s_and_b32 s68, s68, 511
    s_lshl_b32 s72, s68, 1
    v_lshrrev_b32 v183, 3, v1
    v_lshlrev_b32 v184, 10, v4
    v_lshl_add_u32 v184, v183, 1, v184
    buffer_load_ushort v196, v184, s[60:63], s72 offen
    s_lshr_b32 s4, s68, 6
    s_lshl_b32 s4, s4, 11
    s_bfe_u32 s5, s68, 0x20003
    s_lshl_b32 s5, s5, 8
    s_add_u32 s4, s4, s5
    s_bfe_u32 s5, s68, 0x10005
    s_lshl_b32 s5, s5, 7
    s_add_u32 s4, s4, s5
    v_lshrrev_b32 v185, 5, v1
    v_lshlrev_b32 v185, 10, v185
    v_lshl_add_u32 v185, v4, 4, v185
    v_lshlrev_b32 v184, 4, v4
    v_lshl_add_u32 v184, v2, 2, v184
    v_and_b32 v186, 1, v2
    v_lshl_add_u32 v185, v186, 3, v185
    s_lshr_b32 s5, s68, 6
    s_lshl_b32 s5, s5, 10
    s_sub_u32 s5, s4, s5
    s_add_u32 s6, s5, 131072
    s_add_u32 s7, s5, 139264
    s_add_u32 s8, s5, 147456
    s_add_u32 s9, s5, 155648
    s_add_u32 s5, s4, 344064
    s_add_u32 s4, s4, 294912
    s_lshl_b32 s70, s3, 14
    s_cmp_eq_u32 s15, 3
    s_cbranch_scc1 Ltd_83
    s_cmp_ge_u32 s14, 4
    s_cselect_b32 s68, 1, 0
    s_cmp_lt_u32 s2, 244
    s_cselect_b32 s68, s68, 0
    s_cmp_eq_u32 s68, 1
    s_cbranch_scc1 Ltg_82
    s_mov_b32 s52, s24
    s_and_b32 s53, s25, 0xffff
    s_mov_b32 s54, 4194304
    s_mov_b32 s55, 0x20000
    s_lshl_b32 s13, s66, 2
    s_add_u32 s13, s13, s14
    s_mov_b32 s11, s13
    s_mov_b32 s10, 1
    s_cmp_lt_u32 s14, 4
    s_cbranch_scc1 Lw_85
    s_add_u32 s11, s66, 28
    s_sub_u32 s13, s66, 4
    s_lshl_b32 s13, s13, 3
    s_add_u32 s13, s13, 3
    s_lshr_b32 s10, s3, 2
    s_branch Lw_86
Lw_85:
    s_and_b32 s68, s13, 7
    s_cmp_lg_u32 s68, 3
    s_cbranch_scc1 Lw_86
    s_lshr_b32 s10, s3, 2
    s_xor_b32 s10, s10, 1
Lw_86:
    s_and_b32 s12, s13, 0x18
    s_add_u32 s12, s12, s3
    s_lshl_b32 s12, s12, 17
    s_and_b32 s68, s13, 7
    s_lshl_b32 s68, s68, 7
    s_add_u32 s12, s12, s68
    v_lshrrev_b32 v180, 3, v1
    v_lshlrev_b32 v180, 10, v180
    v_lshl_add_u32 v180, v4, 4, v180
    s_cmp_eq_u32 s10, 1
    s_cselect_b32 s54, s54, 0
    s_mov_b32 s48, s24
    s_and_b32 s49, s25, 0xffff
    s_mov_b32 s50, 0
    s_mov_b32 s51, 0x20000
    s_mov_b32 s50, s54
    s_add_u32 s13, s12, 65536
    s_mov_b32 s10, 8192
    s_branch Lte_84
Ltg_82:
    s_mov_b32 s52, s28
    s_and_b32 s53, s29, 0xffff
    s_mov_b32 s54, 1835008
    s_mov_b32 s55, 0x20000
    s_sub_u32 s13, s14, 4
    s_lshl_b32 s13, s13, 3
    s_add_u32 s13, s13, s66
    s_mul_i32 s12, s3, 229376
    s_lshl_b32 s68, s13, 7
    s_add_u32 s12, s12, s68
    v_lshrrev_b32 v180, 3, v1
    v_mul_u32_u24 v180, 3584, v180
    v_lshl_add_u32 v180, v4, 4, v180
    s_mov_b32 s48, s28
    s_and_b32 s49, s29, 0xffff
    s_mov_b32 s50, 1835008
    s_mov_b32 s51, 0x20000
    s_mov_b32 s52, s30
    s_and_b32 s53, s31, 0xffff
    s_mov_b32 s54, 1835008
    s_mov_b32 s55, 0x20000
    s_mov_b32 s13, s12
    s_mov_b32 s10, 28672
    s_branch Lte_84
Ltd_83:
    s_mov_b32 s48, s32
    s_and_b32 s49, s33, 0xffff
    s_mov_b32 s50, 1835008
    s_mov_b32 s51, 0x20000
    s_mov_b32 s52, s32
    s_and_b32 s53, s33, 0xffff
    s_mov_b32 s54, 1835008
    s_mov_b32 s55, 0x20000
    s_lshl_b32 s12, s66, 1
    s_add_u32 s12, s12, s14
    s_lshl_b32 s12, s12, 6
    s_lshl_b32 s68, s3, 18
    s_add_u32 s12, s12, s68
    s_add_u32 s13, s12, 131072
    s_mov_b32 s10, 16384
    v_lshrrev_b32 v180, 2, v1
    v_lshlrev_b32 v180, 10, v180
    v_and_b32 v10, 3, v1
    v_lshl_add_u32 v180, v10, 4, v180
Lte_84:
    s_waitcnt vmcnt(3)
    s_mul_i32 s68, s10, 0
    s_add_u32 s68, s68, s13
    s_add_u32 m0, s70, 8192
    s_nop 0
    buffer_load_dwordx4 v180, s[52:55], s68 offen nt lds
    s_waitcnt vmcnt(3)
    s_mul_i32 s68, s10, 1
    s_add_u32 s68, s68, s13
    s_add_u32 m0, s70, 9216
    s_nop 0
    buffer_load_dwordx4 v180, s[52:55], s68 offen nt lds
    s_waitcnt vmcnt(3)
    s_mul_i32 s68, s10, 2
    s_add_u32 s68, s68, s13
    s_add_u32 m0, s70, 10240
    s_nop 0
    buffer_load_dwordx4 v180, s[52:55], s68 offen nt lds
    s_waitcnt vmcnt(3)
    s_mul_i32 s68, s10, 3
    s_add_u32 s68, s68, s13
    s_add_u32 m0, s70, 11264
    s_nop 0
    buffer_load_dwordx4 v180, s[52:55], s68 offen nt lds
    s_waitcnt vmcnt(3)
    s_mul_i32 s68, s10, 4
    s_add_u32 s68, s68, s13
    s_add_u32 m0, s70, 12288
    s_nop 0
    buffer_load_dwordx4 v180, s[52:55], s68 offen nt lds
    s_waitcnt vmcnt(3)
    s_mul_i32 s68, s10, 5
    s_add_u32 s68, s68, s13
    s_add_u32 m0, s70, 13312
    s_nop 0
    buffer_load_dwordx4 v180, s[52:55], s68 offen nt lds
    s_waitcnt vmcnt(3)
    s_mul_i32 s68, s10, 6
    s_add_u32 s68, s68, s13
    s_add_u32 m0, s70, 14336
    s_nop 0
    buffer_load_dwordx4 v180, s[52:55], s68 offen nt lds
    s_waitcnt vmcnt(3)
    s_mul_i32 s68, s10, 7
    s_add_u32 s68, s68, s13
    s_add_u32 m0, s70, 15360
    s_nop 0
    buffer_load_dwordx4 v180, s[52:55], s68 offen nt lds
    v_lshlrev_b32 v182, 6, v5
    v_lshl_add_u32 v182, v4, 3, v182
    v_add_u32 v182, s70, v182
    v_lshlrev_b32 v181, 9, v3
    v_lshl_add_u32 v181, v2, 7, v181
    v_lshl_add_u32 v181, v4, 4, v181
    s_lshl_b32 s71, s3, 12
    s_add_u32 s71, s71, 212992
    v_and_b32 v186, 1, v2
    v_lshrrev_b32 v10, 5, v1
    s_lshl_b32 s68, s3, 11
    v_add_u32 v11, 0, v186
    v_xor_b32 v12, v11, v4
    v_lshl_add_u32 v11, v11, 3, v12
    v_lshlrev_b32 v11, 4, v11
    v_lshl_add_u32 v11, v10, 10, v11
    v_add_u32 v188, s68, v11
    v_add_u32 v11, 2, v186
    v_xor_b32 v12, v11, v4
    v_lshl_add_u32 v11, v11, 3, v12
    v_lshlrev_b32 v11, 4, v11
    v_lshl_add_u32 v11, v10, 10, v11
    v_add_u32 v189, s68, v11
    v_add_u32 v11, 4, v186
    v_xor_b32 v12, v11, v4
    v_lshl_add_u32 v11, v11, 3, v12
    v_lshlrev_b32 v11, 4, v11
    v_lshl_add_u32 v11, v10, 10, v11
    v_add_u32 v190, s68, v11
    v_add_u32 v11, 6, v186
    v_xor_b32 v12, v11, v4
    v_lshl_add_u32 v11, v11, 3, v12
    v_lshlrev_b32 v11, 4, v11
    v_lshl_add_u32 v11, v10, 10, v11
    v_add_u32 v191, s68, v11
    v_bfe_u32 v11, v1, 2, 3
    s_lshl_b32 s68, s3, 1
    v_add_u32 v10, s68, v10
    v_and_b32 v10, 7, v10
    v_xor_b32 v10, v10, v11
    v_lshl_add_u32 v10, v11, 3, v10
    v_and_b32 v11, 3, v1
    v_lshlrev_b32 v11, 2, v11
    v_lshl_add_u32 v187, v10, 4, v11
    s_lshl_b32 s73, s69, 11
    s_lshl_b32 s68, s3, 8
    s_add_u32 s73, s73, s68
    s_add_u32 s73, s73, 131072
    s_waitcnt vmcnt(12)
    ds_read_b64 v[20:21], v182 offset:0
    ds_read_b64 v[22:23], v182 offset:64
    ds_read_b64 v[24:25], v182 offset:128
    ds_read_b64 v[26:27], v182 offset:192
    ds_read_b64 v[28:29], v182 offset:256
    ds_read_b64 v[30:31], v182 offset:320
    ds_read_b64 v[32:33], v182 offset:384
    ds_read_b64 v[34:35], v182 offset:448
    s_waitcnt lgkmcnt(0)
    v_perm_b32 v84, v22, v20, s64
    v_perm_b32 v88, v22, v20, s65
    v_perm_b32 v92, v23, v21, s64
    v_perm_b32 v96, v23, v21, s65
    v_perm_b32 v85, v26, v24, s64
    v_perm_b32 v89, v26, v24, s65
    v_perm_b32 v93, v27, v25, s64
    v_perm_b32 v97, v27, v25, s65
    v_perm_b32 v86, v30, v28, s64
    v_perm_b32 v90, v30, v28, s65
    v_perm_b32 v94, v31, v29, s64
    v_perm_b32 v98, v31, v29, s65
    v_perm_b32 v87, v34, v32, s64
    v_perm_b32 v91, v34, v32, s65
    v_perm_b32 v95, v35, v33, s64
    v_perm_b32 v99, v35, v33, s65
    s_waitcnt vmcnt(8)
    ds_read_b64 v[36:37], v182 offset:4096
    ds_read_b64 v[38:39], v182 offset:4160
    ds_read_b64 v[40:41], v182 offset:4224
    ds_read_b64 v[42:43], v182 offset:4288
    ds_read_b64 v[44:45], v182 offset:4352
    ds_read_b64 v[46:47], v182 offset:4416
    ds_read_b64 v[48:49], v182 offset:4480
    ds_read_b64 v[50:51], v182 offset:4544
    s_waitcnt lgkmcnt(0)
    v_perm_b32 v100, v38, v36, s64
    v_perm_b32 v104, v38, v36, s65
    v_perm_b32 v108, v39, v37, s64
    v_perm_b32 v112, v39, v37, s65
    v_perm_b32 v101, v42, v40, s64
    v_perm_b32 v105, v42, v40, s65
    v_perm_b32 v109, v43, v41, s64
    v_perm_b32 v113, v43, v41, s65
    v_perm_b32 v102, v46, v44, s64
    v_perm_b32 v106, v46, v44, s65
    v_perm_b32 v110, v47, v45, s64
    v_perm_b32 v114, v47, v45, s65
    v_perm_b32 v103, v50, v48, s64
    v_perm_b32 v107, v50, v48, s65
    v_perm_b32 v111, v51, v49, s64
    v_perm_b32 v115, v51, v49, s65
    s_waitcnt vmcnt(4)
    ds_read_b64 v[52:53], v182 offset:8192
    ds_read_b64 v[54:55], v182 offset:8256
    ds_read_b64 v[56:57], v182 offset:8320
    ds_read_b64 v[58:59], v182 offset:8384
    ds_read_b64 v[60:61], v182 offset:8448
    ds_read_b64 v[62:63], v182 offset:8512
    ds_read_b64 v[64:65], v182 offset:8576
    ds_read_b64 v[66:67], v182 offset:8640
    s_waitcnt lgkmcnt(0)
    v_perm_b32 v116, v54, v52, s64
    v_perm_b32 v120, v54, v52, s65
    v_perm_b32 v124, v55, v53, s64
    v_perm_b32 v128, v55, v53, s65
    v_perm_b32 v117, v58, v56, s64
    v_perm_b32 v121, v58, v56, s65
    v_perm_b32 v125, v59, v57, s64
    v_perm_b32 v129, v59, v57, s65
    v_perm_b32 v118, v62, v60, s64
    v_perm_b32 v122, v62, v60, s65
    v_perm_b32 v126, v63, v61, s64
    v_perm_b32 v130, v63, v61, s65
    v_perm_b32 v119, v66, v64, s64
    v_perm_b32 v123, v66, v64, s65
    v_perm_b32 v127, v67, v65, s64
    v_perm_b32 v131, v67, v65, s65
    s_waitcnt vmcnt(0)
    ds_read_b64 v[68:69], v182 offset:12288
    ds_read_b64 v[70:71], v182 offset:12352
    ds_read_b64 v[72:73], v182 offset:12416
    ds_read_b64 v[74:75], v182 offset:12480
    ds_read_b64 v[76:77], v182 offset:12544
    ds_read_b64 v[78:79], v182 offset:12608
    ds_read_b64 v[80:81], v182 offset:12672
    ds_read_b64 v[82:83], v182 offset:12736
    s_waitcnt lgkmcnt(0)
    v_perm_b32 v132, v70, v68, s64
    v_perm_b32 v136, v70, v68, s65
    v_perm_b32 v140, v71, v69, s64
    v_perm_b32 v144, v71, v69, s65
    v_perm_b32 v133, v74, v72, s64
    v_perm_b32 v137, v74, v72, s65
    v_perm_b32 v141, v75, v73, s64
    v_perm_b32 v145, v75, v73, s65
    v_perm_b32 v134, v78, v76, s64
    v_perm_b32 v138, v78, v76, s65
    v_perm_b32 v142, v79, v77, s64
    v_perm_b32 v146, v79, v77, s65
    v_perm_b32 v135, v82, v80, s64
    v_perm_b32 v139, v82, v80, s65
    v_perm_b32 v143, v83, v81, s64
    v_perm_b32 v147, v83, v81, s65
    s_barrier
    s_cmp_ge_u32 s3, 4
    s_cbranch_scc1 Ldn1_87
    s_mov_b32 s79, 0
Lpoll_88:
    buffer_load_dwordx2 v[200:201], v185, s[44:47], s4 offen sc1
    buffer_load_dwordx2 v[202:203], v185, s[44:47], s5 offen sc1
    s_waitcnt vmcnt(0)
    v_min_u32 v10, v201, v203
    v_max_u32 v11, v201, v203
    v_xor_b32 v10, s78, v10
    v_xor_b32 v11, s78, v11
    v_or_b32 v10, v10, v11
    v_cmp_ne_u32 vcc, 0, v10
    s_cbranch_vccz Ldone_89
    s_sleep 4
    s_add_u32 s79, s79, 1
    s_cmp_lt_u32 s79, 400000
    s_cbranch_scc1 Lpoll_88
Ldone_89:
    v_lshlrev_b32 v11, 4, v3
    v_lshrrev_b32 v200, v11, v200
    v_lshlrev_b32 v200, 16, v200
    v_lshrrev_b32 v202, v11, v202
    v_lshlrev_b32 v202, 16, v202
    v_lshlrev_b32 v196, 16, v196
Ldn1_87:
    s_mov_b64 exec, 0x1
    s_mov_b32 s79, 0
Lpoll_90:
    buffer_load_dword v10, off, s[44:47], s73 sc1
    s_waitcnt vmcnt(0)
    v_cmp_eq_u32 vcc, -1, v10
    s_cbranch_vccz Ldone_91
    s_sleep 1
    s_add_u32 s79, s79, 1
    s_cmp_lt_u32 s79, 400000
    s_cbranch_scc1 Lpoll_90
Ldone_91:
    s_mov_b64 exec, -1
    s_cmp_ge_u32 s3, 4
    s_cbranch_scc1 Ldn2_92
    s_mov_b32 s79, 0
Lpoll_93:
    buffer_load_dword v204, v184, s[44:47], s6 offen sc1
    buffer_load_dword v205, v184, s[44:47], s7 offen sc1
    buffer_load_dword v206, v184, s[44:47], s8 offen sc1
    buffer_load_dword v207, v184, s[44:47], s9 offen sc1
    s_waitcnt vmcnt(0)
    v_max3_u32 v10, v204, v205, v206
    v_max_u32 v10, v10, v207
    v_cmp_eq_u32 vcc, -1, v10
    s_cbranch_vccz Ldone_94
    s_sleep 2
    s_add_u32 s79, s79, 1
    s_cmp_lt_u32 s79, 400000
    s_cbranch_scc1 Lpoll_93
Ldone_94:
    v_lshlrev_b32 v12, 4, v3
    v_lshrrev_b32 v204, v12, v204
    v_lshlrev_b32 v204, 16, v204
    v_lshrrev_b32 v205, v12, v205
    v_lshlrev_b32 v205, 16, v205
    v_lshrrev_b32 v206, v12, v206
    v_lshlrev_b32 v206, 16, v206
    v_lshrrev_b32 v207, v12, v207
    v_lshlrev_b32 v207, 16, v207
    v_add_f32 v204, v204, v205
    v_add_f32 v206, v206, v207
    v_add_f32 v204, v204, v206
    s_lshr_b32 s68, s69, 1
    s_cmp_lg_u32 s68, 3
    s_cbranch_scc1 Lx3_95
    s_add_u32 s6, s6, 29696
    s_add_u32 s7, s7, 22528
    s_add_u32 s8, s8, 15360
    s_add_u32 s9, s9, 8192
    s_mov_b32 s79, 0
Lpoll_96:
    buffer_load_dword v208, v184, s[44:47], s6 offen sc1
    buffer_load_dword v209, v184, s[44:47], s7 offen sc1
    buffer_load_dword v210, v184, s[44:47], s8 offen sc1
    buffer_load_dword v211, v184, s[44:47], s9 offen sc1
    s_waitcnt vmcnt(0)
    v_max3_u32 v10, v208, v209, v210
    v_max_u32 v10, v10, v211
    v_cmp_eq_u32 vcc, -1, v10
    s_cbranch_vccz Ldone_97
    s_sleep 2
    s_add_u32 s79, s79, 1
    s_cmp_lt_u32 s79, 400000
    s_cbranch_scc1 Lpoll_96
Ldone_97:
    v_lshrrev_b32 v208, v12, v208
    v_lshlrev_b32 v208, 16, v208
    v_lshrrev_b32 v209, v12, v209
    v_lshlrev_b32 v209, 16, v209
    v_lshrrev_b32 v210, v12, v210
    v_lshlrev_b32 v210, 16, v210
    v_lshrrev_b32 v211, v12, v211
    v_lshlrev_b32 v211, 16, v211
    v_add_f32 v208, v208, v209
    v_add_f32 v210, v210, v211
    v_add_f32 v208, v208, v210
    v_add_f32 v204, v204, v208
Lx3_95:
    v_fma_f32 v204, v204, v200, v196
    v_lshlrev_b32 v180, 10, v4
    v_lshl_add_u32 v180, v2, 2, v180
Ldn2_92:
    s_cmp_eq_u32 s3, 7
    s_cbranch_scc1 Ldn7_98
    s_mov_b32 s79, 0
Lpoll_99:
    buffer_load_dwordx4 v[148:151], v181, s[44:47], s71 offen offset:0 sc1
    buffer_load_dwordx4 v[152:155], v181, s[44:47], s71 offen offset:1024 sc1
    buffer_load_dwordx4 v[156:159], v181, s[44:47], s71 offen offset:2048 sc1
    buffer_load_dwordx4 v[160:163], v181, s[44:47], s71 offen offset:3072 sc1
    s_waitcnt vmcnt(0)
    v_mfma_f32_16x16x32_bf16 v[164:167], v[148:151], v[84:87], 0
    v_mfma_f32_16x16x32_bf16 v[168:171], v[148:151], v[88:91], 0
    v_mfma_f32_16x16x32_bf16 v[172:175], v[148:151], v[92:95], 0
    v_mfma_f32_16x16x32_bf16 v[176:179], v[148:151], v[96:99], 0
    v_mfma_f32_16x16x32_bf16 v[164:167], v[152:155], v[100:103], v[164:167]
    v_mfma_f32_16x16x32_bf16 v[168:171], v[152:155], v[104:107], v[168:171]
    v_mfma_f32_16x16x32_bf16 v[172:175], v[152:155], v[108:111], v[172:175]
    v_mfma_f32_16x16x32_bf16 v[176:179], v[152:155], v[112:115], v[176:179]
    v_max3_u32 v10, v148, v149, v150
    v_max3_u32 v10, v10, v151, v152
    v_max3_u32 v10, v10, v153, v154
    v_max_u32 v10, v10, v155
    v_max3_u32 v11, v156, v157, v158
    v_max3_u32 v11, v11, v159, v160
    v_max3_u32 v11, v11, v161, v162
    v_max_u32 v11, v11, v163
    v_max_u32 v10, v10, v11
    v_cmp_eq_u32 vcc, -1, v10
    s_cbranch_vccz Ldone_100
    s_sleep 2
    s_add_u32 s79, s79, 1
    s_cmp_lt_u32 s79, 400000
    s_cbranch_scc1 Lpoll_99
Ldone_100:
    v_mfma_f32_16x16x32_bf16 v[164:167], v[156:159], v[116:119], v[164:167]
    v_mfma_f32_16x16x32_bf16 v[168:171], v[156:159], v[120:123], v[168:171]
    v_mfma_f32_16x16x32_bf16 v[172:175], v[156:159], v[124:127], v[172:175]
    v_mfma_f32_16x16x32_bf16 v[176:179], v[156:159], v[128:131], v[176:179]
    v_mfma_f32_16x16x32_bf16 v[164:167], v[160:163], v[132:135], v[164:167]
    v_mfma_f32_16x16x32_bf16 v[168:171], v[160:163], v[136:139], v[168:171]
    v_mfma_f32_16x16x32_bf16 v[172:175], v[160:163], v[140:143], v[172:175]
    v_mfma_f32_16x16x32_bf16 v[176:179], v[160:163], v[144:147], v[176:179]
    s_mov_b32 exec_lo, 0xff00ff
    s_mov_b32 exec_hi, 0xff00ff00
    s_nop 2
    ds_write_b128 v188, v[164:167]
    ds_write_b128 v189, v[168:171]
    ds_write_b128 v190, v[172:175]
    ds_write_b128 v191, v[176:179]
    s_mov_b64 exec, -1
Ldn7_98:
    s_waitcnt lgkmcnt(0)
    s_barrier
    s_cmp_ge_u32 s3, 4
    s_cbranch_scc1 Ldn_101
    ds_read2st64_b32 v[20:21], v187 offset0:0 offset1:4
    ds_read2st64_b32 v[22:23], v187 offset0:8 offset1:12
    ds_read2st64_b32 v[24:25], v187 offset0:16 offset1:20
    ds_read2st64_b32 v[26:27], v187 offset0:24 offset1:28
    ds_read2st64_b32 v[28:29], v187 offset0:32 offset1:36
    ds_read2st64_b32 v[30:31], v187 offset0:40 offset1:44
    ds_read2st64_b32 v[32:33], v187 offset0:48 offset1:52
    s_waitcnt lgkmcnt(5)
    v_pk_add_f32 v[20:21], v[20:21], v[22:23]
    s_waitcnt lgkmcnt(4)
    v_pk_add_f32 v[20:21], v[20:21], v[24:25]
    s_waitcnt lgkmcnt(3)
    v_pk_add_f32 v[20:21], v[20:21], v[26:27]
    s_waitcnt lgkmcnt(2)
    v_pk_add_f32 v[20:21], v[20:21], v[28:29]
    s_waitcnt lgkmcnt(1)
    v_pk_add_f32 v[20:21], v[20:21], v[30:31]
    s_waitcnt lgkmcnt(0)
    v_pk_add_f32 v[20:21], v[20:21], v[32:33]
    v_add_f32 v198, v20, v21
    v_fma_f32 v198, v198, v202, v204
    s_nop 1
    v_mov_b32_dpp v199, v198 row_ror:8 row_mask:0xf bank_mask:0xf
    v_cvt_pk_bf16_f32 v198, v198, v199
    s_mov_b32 exec_lo, 0xff00ff
    s_mov_b32 exec_hi, 0xff00ff
    buffer_store_dword v198, v180, s[56:59], s72 offen
Ldn_101:
    s_cmp_lg_u32 s69, 0
    s_cbranch_scc1 Lep_102
    s_cmp_lg_u32 s3, 7
    s_cbranch_scc1 Lep_102
    s_mov_b64 exec, 1
    v_mov_b32 v10, s78
    buffer_store_dword v10, off, s[44:47], 0 offset:0 sc1
Lep_102:
    s_endpgm
L_GU:
    s_sub_u32 s70, s14, 4
    s_lshl_b32 s70, s70, 3
    s_add_u32 s70, s70, s66
    s_lshl_b32 s69, s70, 10
    s_lshl_b32 s68, s3, 7
    s_add_u32 s69, s69, s68
    s_add_u32 s69, s69, 212992
    s_mov_b32 s56, s16
    s_and_b32 s57, s17, 0xffff
    s_mov_b32 s58, 8192
    s_mov_b32 s59, 0x20000
    v_lshlrev_b32 v220, 10, v4
    v_lshl_add_u32 v220, v5, 1, v220
    s_lshl_b32 s68, s3, 7
    buffer_load_dwordx4 v[148:151], v220, s[56:59], s68 offen
    s_lshl_b32 s73, s3, 11
    s_add_u32 s73, s73, 294912
    s_add_u32 s4, s73, 16384
    s_add_u32 s5, s73, 32768
    v_lshrrev_b32 v221, 3, v1
    v_mul_u32_u24 v221, 3584, v221
    v_lshl_add_u32 v221, v4, 4, v221
    s_mul_i32 s71, s3, 229376
    s_lshl_b32 s68, s70, 7
    s_add_u32 s71, s71, s68
    s_lshl_b32 s72, s3, 14
    buffer_load_dwordx4 v[84:87], v7, s[44:47], s73 offen offset:0 sc1
    buffer_load_dwordx4 v[88:91], v7, s[44:47], s73 offen offset:1024 sc1
    buffer_load_dwordx4 v[92:95], v7, s[44:47], s4 offen offset:0 sc1
    buffer_load_dwordx4 v[96:99], v7, s[44:47], s4 offen offset:1024 sc1
    buffer_load_dwordx4 v[100:103], v7, s[44:47], s5 offen offset:0 sc1
    buffer_load_dwordx4 v[104:107], v7, s[44:47], s5 offen offset:1024 sc1
    s_cmp_eq_u32 s15, 3
    s_cbranch_scc1 Ltd_104
    s_cmp_ge_u32 s14, 4
    s_cselect_b32 s68, 1, 0
    s_cmp_lt_u32 s2, 244
    s_cselect_b32 s68, s68, 0
    s_cmp_eq_u32 s68, 1
    s_cbranch_scc1 Ltg_103
    s_mov_b32 s52, s24
    s_and_b32 s53, s25, 0xffff
    s_mov_b32 s54, 4194304
    s_mov_b32 s55, 0x20000
    s_lshl_b32 s13, s66, 2
    s_add_u32 s13, s13, s14
    s_mov_b32 s11, s13
    s_mov_b32 s10, 1
    s_cmp_lt_u32 s14, 4
    s_cbranch_scc1 Lw_106
    s_add_u32 s11, s66, 28
    s_sub_u32 s13, s66, 4
    s_lshl_b32 s13, s13, 3
    s_add_u32 s13, s13, 3
    s_lshr_b32 s10, s3, 2
    s_branch Lw_107
Lw_106:
    s_and_b32 s68, s13, 7
    s_cmp_lg_u32 s68, 3
    s_cbranch_scc1 Lw_107
    s_lshr_b32 s10, s3, 2
    s_xor_b32 s10, s10, 1
Lw_107:
    s_and_b32 s12, s13, 0x18
    s_add_u32 s12, s12, s3
    s_lshl_b32 s12, s12, 17
    s_and_b32 s68, s13, 7
    s_lshl_b32 s68, s68, 7
    s_add_u32 s12, s12, s68
    v_lshrrev_b32 v221, 3, v1
    v_lshlrev_b32 v221, 10, v221
    v_lshl_add_u32 v221, v4, 4, v221
    s_cmp_eq_u32 s10, 1
    s_cselect_b32 s54, s54, 0
    s_mov_b32 s48, s24
    s_and_b32 s49, s25, 0xffff
    s_mov_b32 s50, 0
    s_mov_b32 s51, 0x20000
    s_mov_b32 s50, s54
    s_add_u32 s13, s12, 65536
    s_mov_b32 s10, 8192
    s_branch Lte_105
Ltg_103:
    s_mov_b32 s52, s28
    s_and_b32 s53, s29, 0xffff
    s_mov_b32 s54, 1835008
    s_mov_b32 s55, 0x20000
    s_sub_u32 s13, s14, 4
    s_lshl_b32 s13, s13, 3
    s_add_u32 s13, s13, s66
    s_mul_i32 s12, s3, 229376
    s_lshl_b32 s68, s13, 7
    s_add_u32 s12, s12, s68
    v_lshrrev_b32 v221, 3, v1
    v_mul_u32_u24 v221, 3584, v221
    v_lshl_add_u32 v221, v4, 4, v221
    s_mov_b32 s48, s28
    s_and_b32 s49, s29, 0xffff
    s_mov_b32 s50, 1835008
    s_mov_b32 s51, 0x20000
    s_mov_b32 s52, s30
    s_and_b32 s53, s31, 0xffff
    s_mov_b32 s54, 1835008
    s_mov_b32 s55, 0x20000
    s_mov_b32 s13, s12
    s_mov_b32 s10, 28672
    s_branch Lte_105
Ltd_104:
    s_mov_b32 s48, s32
    s_and_b32 s49, s33, 0xffff
    s_mov_b32 s50, 1835008
    s_mov_b32 s51, 0x20000
    s_mov_b32 s52, s32
    s_and_b32 s53, s33, 0xffff
    s_mov_b32 s54, 1835008
    s_mov_b32 s55, 0x20000
    s_lshl_b32 s12, s66, 1
    s_add_u32 s12, s12, s14
    s_lshl_b32 s12, s12, 6
    s_lshl_b32 s68, s3, 18
    s_add_u32 s12, s12, s68
    s_add_u32 s13, s12, 131072
    s_mov_b32 s10, 16384
    v_lshrrev_b32 v221, 2, v1
    v_lshlrev_b32 v221, 10, v221
    v_and_b32 v10, 3, v1
    v_lshl_add_u32 v221, v10, 4, v221
Lte_105:
    s_waitcnt vmcnt(3)
    s_mul_i32 s68, s10, 0
    s_add_u32 s68, s68, s13
    s_add_u32 m0, s72, 8192
    s_nop 0
    buffer_load_dwordx4 v221, s[52:55], s68 offen nt lds
    s_waitcnt vmcnt(3)
    s_mul_i32 s68, s10, 1
    s_add_u32 s68, s68, s13
    s_add_u32 m0, s72, 9216
    s_nop 0
    buffer_load_dwordx4 v221, s[52:55], s68 offen nt lds
    s_waitcnt vmcnt(3)
    s_mul_i32 s68, s10, 2
    s_add_u32 s68, s68, s13
    s_add_u32 m0, s72, 10240
    s_nop 0
    buffer_load_dwordx4 v221, s[52:55], s68 offen nt lds
    s_waitcnt vmcnt(3)
    s_mul_i32 s68, s10, 3
    s_add_u32 s68, s68, s13
    s_add_u32 m0, s72, 11264
    s_nop 0
    buffer_load_dwordx4 v221, s[52:55], s68 offen nt lds
    s_waitcnt vmcnt(3)
    s_mul_i32 s68, s10, 4
    s_add_u32 s68, s68, s13
    s_add_u32 m0, s72, 12288
    s_nop 0
    buffer_load_dwordx4 v221, s[52:55], s68 offen nt lds
    s_waitcnt vmcnt(3)
    s_mul_i32 s68, s10, 5
    s_add_u32 s68, s68, s13
    s_add_u32 m0, s72, 13312
    s_nop 0
    buffer_load_dwordx4 v221, s[52:55], s68 offen nt lds
    s_waitcnt vmcnt(3)
    s_mul_i32 s68, s10, 6
    s_add_u32 s68, s68, s13
    s_add_u32 m0, s72, 14336
    s_nop 0
    buffer_load_dwordx4 v221, s[52:55], s68 offen nt lds
    s_waitcnt vmcnt(3)
    s_mul_i32 s68, s10, 7
    s_add_u32 s68, s68, s13
    s_add_u32 m0, s72, 15360
    s_nop 0
    buffer_load_dwordx4 v221, s[52:55], s68 offen nt lds
    s_waitcnt vmcnt(8)
    v_min3_u32 v10, v85, v87, v89
    v_min3_u32 v10, v10, v91, v93
    v_min3_u32 v10, v10, v95, v97
    v_min3_u32 v10, v10, v99, v101
    v_min3_u32 v10, v10, v103, v105
    v_min_u32 v10, v10, v107
    v_max3_u32 v11, v85, v87, v89
    v_max3_u32 v11, v11, v91, v93
    v_max3_u32 v11, v11, v95, v97
    v_max3_u32 v11, v11, v99, v101
    v_max3_u32 v11, v11, v103, v105
    v_max_u32 v11, v11, v107
    v_xor_b32 v10, s78, v10
    v_xor_b32 v11, s78, v11
    v_or_b32 v10, v10, v11
    v_cmp_ne_u32 vcc, 0, v10
    s_cbranch_vccz Lm_108
    s_mov_b32 s79, 0
Lpoll_109:
    buffer_load_dwordx4 v[84:87], v7, s[44:47], s73 offen offset:0 sc1
    buffer_load_dwordx4 v[88:91], v7, s[44:47], s73 offen offset:1024 sc1
    buffer_load_dwordx4 v[92:95], v7, s[44:47], s4 offen offset:0 sc1
    buffer_load_dwordx4 v[96:99], v7, s[44:47], s4 offen offset:1024 sc1
    buffer_load_dwordx4 v[100:103], v7, s[44:47], s5 offen offset:0 sc1
    buffer_load_dwordx4 v[104:107], v7, s[44:47], s5 offen offset:1024 sc1
    s_waitcnt vmcnt(0)
    v_min3_u32 v10, v85, v87, v89
    v_min3_u32 v10, v10, v91, v93
    v_min3_u32 v10, v10, v95, v97
    v_min3_u32 v10, v10, v99, v101
    v_min3_u32 v10, v10, v103, v105
    v_min_u32 v10, v10, v107
    v_max3_u32 v11, v85, v87, v89
    v_max3_u32 v11, v11, v91, v93
    v_max3_u32 v11, v11, v95, v97
    v_max3_u32 v11, v11, v99, v101
    v_max3_u32 v11, v11, v103, v105
    v_max_u32 v11, v11, v107
    v_xor_b32 v10, s78, v10
    v_xor_b32 v11, s78, v11
    v_or_b32 v10, v10, v11
    v_cmp_ne_u32 vcc, 0, v10
    s_cbranch_vccz Ldone_110
    s_sleep 4
    s_add_u32 s79, s79, 1
    s_cmp_lt_u32 s79, 400000
    s_cbranch_scc1 Lpoll_109
Ldone_110:
Lm_108:
    v_lshlrev_b32 v9, 6, v4
    v_add_u32 v9, 147456, v9
    s_lshl_b32 s68, s3, 3
    v_add_u32 v8, s68, v9
    v_lshlrev_b32 v196, 16, v148
    v_and_b32 v197, 0xffff0000, v148
    v_lshlrev_b32 v198, 16, v149
    v_and_b32 v199, 0xffff0000, v149
    v_lshlrev_b32 v200, 16, v150
    v_and_b32 v201, 0xffff0000, v150
    v_lshlrev_b32 v202, 16, v151
    v_and_b32 v203, 0xffff0000, v151
    v_lshlrev_b32 v188, 16, v84
    v_and_b32 v189, 0xffff0000, v84
    v_mov_b32 v184, v92
    v_lshlrev_b32 v190, 16, v86
    v_and_b32 v191, 0xffff0000, v86
    v_mov_b32 v185, v94
    v_lshlrev_b32 v192, 16, v88
    v_and_b32 v193, 0xffff0000, v88
    v_mov_b32 v186, v96
    v_lshlrev_b32 v194, 16, v90
    v_and_b32 v195, 0xffff0000, v90
    v_mov_b32 v187, v98
    v_lshlrev_b32 v176, 16, v100
    v_and_b32 v177, 0xffff0000, v100
    v_lshlrev_b32 v178, 16, v102
    v_and_b32 v179, 0xffff0000, v102
    v_lshlrev_b32 v180, 16, v104
    v_and_b32 v181, 0xffff0000, v104
    v_lshlrev_b32 v182, 16, v106
    v_and_b32 v183, 0xffff0000, v106
    v_pk_add_f32 v[176:177], v[176:177], 1.0 op_sel_hi:[1,0]
    v_pk_add_f32 v[178:179], v[178:179], 1.0 op_sel_hi:[1,0]
    v_pk_add_f32 v[180:181], v[180:181], 1.0 op_sel_hi:[1,0]
    v_pk_add_f32 v[182:183], v[182:183], 1.0 op_sel_hi:[1,0]
    v_cvt_pk_bf16_f32 v176, 0, v176
    v_cvt_pk_bf16_f32 v177, 0, v177
    v_cvt_pk_bf16_f32 v178, 0, v178
    v_cvt_pk_bf16_f32 v179, 0, v179
    v_cvt_pk_bf16_f32 v180, 0, v180
    v_cvt_pk_bf16_f32 v181, 0, v181
    v_cvt_pk_bf16_f32 v182, 0, v182
    v_cvt_pk_bf16_f32 v183, 0, v183
    v_pk_add_f32 v[116:117], v[196:197], v[198:199]
    v_pk_mul_f32 v[118:119], v[196:197], v[196:197]
    v_pk_add_f32 v[120:121], v[200:201], v[202:203]
    v_pk_fma_f32 v[118:119], v[198:199], v[198:199], v[118:119]
    v_pk_fma_f32 v[118:119], v[200:201], v[200:201], v[118:119]
    v_pk_fma_f32 v[118:119], v[202:203], v[202:203], v[118:119]
    v_pk_add_f32 v[116:117], v[116:117], v[120:121]
    v_add_f32 v120, v116, v117
    v_add_f32 v121, v118, v119
    s_nop 0
    v_add_f32_dpp v120, v120, v120 row_ror:8 row_mask:0xf bank_mask:0xf
    v_add_f32_dpp v121, v121, v121 row_ror:8 row_mask:0xf bank_mask:0xf
    v_mov_b32 v122, v120
    v_mov_b32 v123, v121
    s_nop 0
    v_permlane16_swap_b32 v120, v122
    v_permlane16_swap_b32 v121, v123
    v_add_f32 v120, v120, v122
    v_add_f32 v121, v121, v123
    v_mov_b32 v122, v120
    v_mov_b32 v123, v121
    s_nop 0
    v_permlane32_swap_b32 v120, v122
    v_permlane32_swap_b32 v121, v123
    v_add_f32 v120, v120, v122
    v_add_f32 v121, v121, v123
    s_mov_b64 exec, 0xff
    ds_write_b64 v8, v[120:121]
    s_mov_b64 exec, -1
    s_waitcnt lgkmcnt(0)
    s_barrier
    ds_read_b128 v[116:119], v9 offset:0
    ds_read_b128 v[120:123], v9 offset:16
    ds_read_b128 v[124:127], v9 offset:32
    ds_read_b128 v[128:131], v9 offset:48
    s_waitcnt lgkmcnt(2)
    v_pk_add_f32 v[116:117], v[116:117], v[118:119]
    v_pk_add_f32 v[120:121], v[120:121], v[122:123]
    s_waitcnt lgkmcnt(0)
    v_pk_add_f32 v[124:125], v[124:125], v[126:127]
    v_pk_add_f32 v[128:129], v[128:129], v[130:131]
    v_pk_add_f32 v[116:117], v[116:117], v[120:121]
    v_pk_add_f32 v[124:125], v[124:125], v[128:129]
    v_pk_add_f32 v[234:235], v[116:117], v[124:125]
    v_mul_f32 v236, 0x3b000000, v234
    v_sub_f32 v196, v196, v236
    v_sub_f32 v197, v197, v236
    v_sub_f32 v198, v198, v236
    v_sub_f32 v199, v199, v236
    v_sub_f32 v200, v200, v236
    v_sub_f32 v201, v201, v236
    v_sub_f32 v202, v202, v236
    v_sub_f32 v203, v203, v236
    v_and_b32 v10, 15, v1
    v_lshlrev_b32 v10, 3, v10
    v_lshl_add_u32 v10, v2, 10, v10
    v_add_u32 v229, s72, v10
    v_and_b32 v10, 15, v1
    v_and_b32 v11, 1, v2
    v_xor_b32 v10, v10, v11
    s_mul_i32 s68, s3, 4096
    v_xor_b32 v12, 0, v10
    v_lshl_add_u32 v12, v2, 4, v12
    v_lshlrev_b32 v12, 4, v12
    v_add_u32 v12, 0, v12
    v_add_u32 v222, s68, v12
    v_xor_b32 v12, 2, v10
    v_lshl_add_u32 v12, v2, 4, v12
    v_lshlrev_b32 v12, 4, v12
    v_add_u32 v12, 1024, v12
    v_add_u32 v223, s68, v12
    v_xor_b32 v12, 4, v10
    v_lshl_add_u32 v12, v2, 4, v12
    v_lshlrev_b32 v12, 4, v12
    v_add_u32 v12, 2048, v12
    v_add_u32 v224, s68, v12
    v_xor_b32 v12, 6, v10
    v_lshl_add_u32 v12, v2, 4, v12
    v_lshlrev_b32 v12, 4, v12
    v_add_u32 v12, 3072, v12
    v_add_u32 v225, s68, v12
    v_bfe_u32 v10, v1, 3, 2
    v_lshrrev_b32 v12, 5, v1
    v_bfe_u32 v11, v1, 2, 1
    s_lshl_b32 s68, s3, 1
    v_add_u32 v12, s68, v12
    v_lshl_add_u32 v13, v10, 1, v11
    v_xor_b32 v12, v12, v13
    v_lshl_add_u32 v12, v11, 4, v12
    v_mul_u32_u24 v10, 64, v10
    v_add_u32 v12, v12, v10
    v_and_b32 v11, 3, v1
    v_lshlrev_b32 v11, 2, v11
    v_lshl_add_u32 v226, v12, 4, v11
    s_lshl_b32 s6, s3, 10
    s_add_u32 s6, s6, 131072
    s_add_u32 s7, s6, 8192
    s_add_u32 s8, s6, 16384
    s_add_u32 s9, s6, 24576
    v_lshlrev_b32 v227, 4, v4
    v_lshl_add_u32 v227, v2, 2, v227
    v_lshlrev_b32 v228, 13, v1
    s_and_b32 s74, s70, 7
    s_lshl_b32 s74, s74, 7
    s_add_u32 s74, s74, s6
    v_mov_b32 v152, 0
    v_mov_b32 v153, 0
    v_mov_b32 v154, 0
    v_mov_b32 v155, 0
    v_mov_b32 v156, 0
    v_mov_b32 v157, 0
    v_mov_b32 v158, 0
    v_mov_b32 v159, 0
    v_mov_b32 v160, 0
    v_mov_b32 v161, 0
    v_mov_b32 v162, 0
    v_mov_b32 v163, 0
    v_mov_b32 v164, 0
    v_mov_b32 v165, 0
    v_mov_b32 v166, 0
    v_mov_b32 v167, 0
    s_waitcnt vmcnt(12)
    ds_read_b64 v[20:21], v229 offset:0
    ds_read_b64 v[22:23], v229 offset:128
    ds_read_b64 v[24:25], v229 offset:256
    ds_read_b64 v[26:27], v229 offset:384
    ds_read_b64 v[28:29], v229 offset:512
    ds_read_b64 v[30:31], v229 offset:640
    ds_read_b64 v[32:33], v229 offset:768
    ds_read_b64 v[34:35], v229 offset:896
    s_waitcnt lgkmcnt(0)
    v_perm_b32 v84, v22, v20, s64
    v_perm_b32 v88, v22, v20, s65
    v_perm_b32 v92, v23, v21, s64
    v_perm_b32 v96, v23, v21, s65
    v_perm_b32 v85, v26, v24, s64
    v_perm_b32 v89, v26, v24, s65
    v_perm_b32 v93, v27, v25, s64
    v_perm_b32 v97, v27, v25, s65
    v_perm_b32 v86, v30, v28, s64
    v_perm_b32 v90, v30, v28, s65
    v_perm_b32 v94, v31, v29, s64
    v_perm_b32 v98, v31, v29, s65
    v_perm_b32 v87, v34, v32, s64
    v_perm_b32 v91, v34, v32, s65
    v_perm_b32 v95, v35, v33, s64
    v_perm_b32 v99, v35, v33, s65
    s_waitcnt vmcnt(8)
    ds_read_b64 v[36:37], v229 offset:4096
    ds_read_b64 v[38:39], v229 offset:4224
    ds_read_b64 v[40:41], v229 offset:4352
    ds_read_b64 v[42:43], v229 offset:4480
    ds_read_b64 v[44:45], v229 offset:4608
    ds_read_b64 v[46:47], v229 offset:4736
    ds_read_b64 v[48:49], v229 offset:4864
    ds_read_b64 v[50:51], v229 offset:4992
    s_waitcnt lgkmcnt(0)
    v_perm_b32 v100, v38, v36, s64
    v_perm_b32 v104, v38, v36, s65
    v_perm_b32 v108, v39, v37, s64
    v_perm_b32 v112, v39, v37, s65
    v_perm_b32 v101, v42, v40, s64
    v_perm_b32 v105, v42, v40, s65
    v_perm_b32 v109, v43, v41, s64
    v_perm_b32 v113, v43, v41, s65
    v_perm_b32 v102, v46, v44, s64
    v_perm_b32 v106, v46, v44, s65
    v_perm_b32 v110, v47, v45, s64
    v_perm_b32 v114, v47, v45, s65
    v_perm_b32 v103, v50, v48, s64
    v_perm_b32 v107, v50, v48, s65
    v_perm_b32 v111, v51, v49, s64
    v_perm_b32 v115, v51, v49, s65
    s_waitcnt vmcnt(4)
    ds_read_b64 v[52:53], v229 offset:8192
    ds_read_b64 v[54:55], v229 offset:8320
    ds_read_b64 v[56:57], v229 offset:8448
    ds_read_b64 v[58:59], v229 offset:8576
    ds_read_b64 v[60:61], v229 offset:8704
    ds_read_b64 v[62:63], v229 offset:8832
    ds_read_b64 v[64:65], v229 offset:8960
    ds_read_b64 v[66:67], v229 offset:9088
    s_waitcnt lgkmcnt(0)
    v_perm_b32 v116, v54, v52, s64
    v_perm_b32 v120, v54, v52, s65
    v_perm_b32 v124, v55, v53, s64
    v_perm_b32 v128, v55, v53, s65
    v_perm_b32 v117, v58, v56, s64
    v_perm_b32 v121, v58, v56, s65
    v_perm_b32 v125, v59, v57, s64
    v_perm_b32 v129, v59, v57, s65
    v_perm_b32 v118, v62, v60, s64
    v_perm_b32 v122, v62, v60, s65
    v_perm_b32 v126, v63, v61, s64
    v_perm_b32 v130, v63, v61, s65
    v_perm_b32 v119, v66, v64, s64
    v_perm_b32 v123, v66, v64, s65
    v_perm_b32 v127, v67, v65, s64
    v_perm_b32 v131, v67, v65, s65
    s_waitcnt vmcnt(0)
    ds_read_b64 v[68:69], v229 offset:12288
    ds_read_b64 v[70:71], v229 offset:12416
    ds_read_b64 v[72:73], v229 offset:12544
    ds_read_b64 v[74:75], v229 offset:12672
    ds_read_b64 v[76:77], v229 offset:12800
    ds_read_b64 v[78:79], v229 offset:12928
    ds_read_b64 v[80:81], v229 offset:13056
    ds_read_b64 v[82:83], v229 offset:13184
    s_waitcnt lgkmcnt(0)
    v_perm_b32 v132, v70, v68, s64
    v_perm_b32 v136, v70, v68, s65
    v_perm_b32 v140, v71, v69, s64
    v_perm_b32 v144, v71, v69, s65
    v_perm_b32 v133, v74, v72, s64
    v_perm_b32 v137, v74, v72, s65
    v_perm_b32 v141, v75, v73, s64
    v_perm_b32 v145, v75, v73, s65
    v_perm_b32 v134, v78, v76, s64
    v_perm_b32 v138, v78, v76, s65
    v_perm_b32 v142, v79, v77, s64
    v_perm_b32 v146, v79, v77, s65
    v_perm_b32 v135, v82, v80, s64
    v_perm_b32 v139, v82, v80, s65
    v_perm_b32 v143, v83, v81, s64
    v_perm_b32 v147, v83, v81, s65
    s_barrier
    v_cvt_pk_bf16_f32 v148, v176, v177
    v_cvt_pk_bf16_f32 v149, v178, v179
    v_cvt_pk_bf16_f32 v150, v180, v181
    v_cvt_pk_bf16_f32 v151, v182, v183
    s_mov_b32 exec_lo, 0xff00ff
    s_mov_b32 exec_hi, 0xff00ff
    v_mov_b32 v152, v148
    v_mov_b32 v153, v149
    v_mov_b32 v154, v150
    v_mov_b32 v155, v151
    s_mov_b32 exec_lo, 0xff00ff00
    s_mov_b32 exec_hi, 0xff00ff00
    v_mov_b32 v164, v148
    v_mov_b32 v165, v149
    v_mov_b32 v166, v150
    v_mov_b32 v167, v151
    s_mov_b64 exec, -1
    v_mfma_f32_16x16x32_bf16 v[204:207], v[152:155], v[84:87], 0
    v_mfma_f32_16x16x32_bf16 v[208:211], v[152:155], v[88:91], 0
    v_mfma_f32_16x16x32_bf16 v[212:215], v[152:155], v[92:95], 0
    v_mfma_f32_16x16x32_bf16 v[216:219], v[152:155], v[96:99], 0
    v_mov_b32_dpp v156, v148 row_ror:8 row_mask:0xf bank_mask:0x3
    v_mov_b32_dpp v157, v149 row_ror:8 row_mask:0xf bank_mask:0x3
    v_mov_b32_dpp v158, v150 row_ror:8 row_mask:0xf bank_mask:0x3
    v_mov_b32_dpp v159, v151 row_ror:8 row_mask:0xf bank_mask:0x3
    v_mov_b32_dpp v160, v148 row_ror:8 row_mask:0xf bank_mask:0xc
    v_mov_b32_dpp v161, v149 row_ror:8 row_mask:0xf bank_mask:0xc
    v_mov_b32_dpp v162, v150 row_ror:8 row_mask:0xf bank_mask:0xc
    v_mov_b32_dpp v163, v151 row_ror:8 row_mask:0xf bank_mask:0xc
    v_mfma_f32_16x16x32_bf16 v[204:207], v[164:167], v[132:135], v[204:207]
    v_mfma_f32_16x16x32_bf16 v[208:211], v[164:167], v[136:139], v[208:211]
    v_mfma_f32_16x16x32_bf16 v[212:215], v[164:167], v[140:143], v[212:215]
    v_mfma_f32_16x16x32_bf16 v[216:219], v[164:167], v[144:147], v[216:219]
    v_mfma_f32_16x16x32_bf16 v[204:207], v[156:159], v[100:103], v[204:207]
    v_mfma_f32_16x16x32_bf16 v[208:211], v[156:159], v[104:107], v[208:211]
    v_mfma_f32_16x16x32_bf16 v[212:215], v[156:159], v[108:111], v[212:215]
    v_mfma_f32_16x16x32_bf16 v[216:219], v[156:159], v[112:115], v[216:219]
    v_mfma_f32_16x16x32_bf16 v[204:207], v[160:163], v[116:119], v[204:207]
    v_mfma_f32_16x16x32_bf16 v[208:211], v[160:163], v[120:123], v[208:211]
    v_mfma_f32_16x16x32_bf16 v[212:215], v[160:163], v[124:127], v[212:215]
    v_mfma_f32_16x16x32_bf16 v[216:219], v[160:163], v[128:131], v[216:219]
    s_nop 4
    ds_write_b128 v222, v[204:207]
    ds_write_b128 v223, v[208:211]
    ds_write_b128 v224, v[212:215]
    ds_write_b128 v225, v[216:219]
    s_waitcnt lgkmcnt(0)
    s_barrier
    ds_read2st64_b32 v[20:21], v226 offset0:0 offset1:2
    ds_read2st64_b32 v[22:23], v226 offset0:16 offset1:18
    ds_read2st64_b32 v[24:25], v226 offset0:32 offset1:34
    ds_read2st64_b32 v[26:27], v226 offset0:48 offset1:50
    ds_read2st64_b32 v[28:29], v226 offset0:64 offset1:66
    ds_read2st64_b32 v[30:31], v226 offset0:80 offset1:82
    ds_read2st64_b32 v[32:33], v226 offset0:96 offset1:98
    ds_read2st64_b32 v[34:35], v226 offset0:112 offset1:114
    s_waitcnt lgkmcnt(6)
    v_pk_add_f32 v[20:21], v[20:21], v[22:23]
    s_waitcnt lgkmcnt(5)
    s_waitcnt lgkmcnt(4)
    v_pk_add_f32 v[24:25], v[24:25], v[26:27]
    s_waitcnt lgkmcnt(3)
    v_pk_add_f32 v[20:21], v[20:21], v[28:29]
    s_waitcnt lgkmcnt(2)
    v_pk_add_f32 v[24:25], v[24:25], v[30:31]
    s_waitcnt lgkmcnt(1)
    v_pk_add_f32 v[20:21], v[20:21], v[32:33]
    s_waitcnt lgkmcnt(0)
    v_pk_add_f32 v[24:25], v[24:25], v[34:35]
    v_pk_add_f32 v[230:231], v[20:21], v[24:25]
    s_barrier
    v_mov_b32 v148, v184
    v_mov_b32 v149, v185
    v_mov_b32 v150, v186
    v_mov_b32 v151, v187
    s_mov_b32 exec_lo, 0xff00ff
    s_mov_b32 exec_hi, 0xff00ff
    v_mov_b32 v152, v148
    v_mov_b32 v153, v149
    v_mov_b32 v154, v150
    v_mov_b32 v155, v151
    s_mov_b32 exec_lo, 0xff00ff00
    s_mov_b32 exec_hi, 0xff00ff00
    v_mov_b32 v164, v148
    v_mov_b32 v165, v149
    v_mov_b32 v166, v150
    v_mov_b32 v167, v151
    s_mov_b64 exec, -1
    v_mfma_f32_16x16x32_bf16 v[204:207], v[152:155], v[84:87], 0
    v_mfma_f32_16x16x32_bf16 v[208:211], v[152:155], v[88:91], 0
    v_mfma_f32_16x16x32_bf16 v[212:215], v[152:155], v[92:95], 0
    v_mfma_f32_16x16x32_bf16 v[216:219], v[152:155], v[96:99], 0
    v_mov_b32_dpp v156, v148 row_ror:8 row_mask:0xf bank_mask:0x3
    v_mov_b32_dpp v157, v149 row_ror:8 row_mask:0xf bank_mask:0x3
    v_mov_b32_dpp v158, v150 row_ror:8 row_mask:0xf bank_mask:0x3
    v_mov_b32_dpp v159, v151 row_ror:8 row_mask:0xf bank_mask:0x3
    v_mov_b32_dpp v160, v148 row_ror:8 row_mask:0xf bank_mask:0xc
    v_mov_b32_dpp v161, v149 row_ror:8 row_mask:0xf bank_mask:0xc
    v_mov_b32_dpp v162, v150 row_ror:8 row_mask:0xf bank_mask:0xc
    v_mov_b32_dpp v163, v151 row_ror:8 row_mask:0xf bank_mask:0xc
    v_mfma_f32_16x16x32_bf16 v[204:207], v[164:167], v[132:135], v[204:207]
    v_mfma_f32_16x16x32_bf16 v[208:211], v[164:167], v[136:139], v[208:211]
    v_mfma_f32_16x16x32_bf16 v[212:215], v[164:167], v[140:143], v[212:215]
    v_mfma_f32_16x16x32_bf16 v[216:219], v[164:167], v[144:147], v[216:219]
    v_mfma_f32_16x16x32_bf16 v[204:207], v[156:159], v[100:103], v[204:207]
    v_mfma_f32_16x16x32_bf16 v[208:211], v[156:159], v[104:107], v[208:211]
    v_mfma_f32_16x16x32_bf16 v[212:215], v[156:159], v[108:111], v[212:215]
    v_mfma_f32_16x16x32_bf16 v[216:219], v[156:159], v[112:115], v[216:219]
    v_mfma_f32_16x16x32_bf16 v[204:207], v[160:163], v[116:119], v[204:207]
    v_mfma_f32_16x16x32_bf16 v[208:211], v[160:163], v[120:123], v[208:211]
    v_mfma_f32_16x16x32_bf16 v[212:215], v[160:163], v[124:127], v[212:215]
    v_mfma_f32_16x16x32_bf16 v[216:219], v[160:163], v[128:131], v[216:219]
    s_nop 4
    ds_write_b128 v222, v[204:207]
    ds_write_b128 v223, v[208:211]
    ds_write_b128 v224, v[212:215]
    ds_write_b128 v225, v[216:219]
    s_waitcnt lgkmcnt(0)
    s_barrier
    ds_read2st64_b32 v[20:21], v226 offset0:0 offset1:2
    ds_read2st64_b32 v[22:23], v226 offset0:16 offset1:18
    ds_read2st64_b32 v[24:25], v226 offset0:32 offset1:34
    ds_read2st64_b32 v[26:27], v226 offset0:48 offset1:50
    ds_read2st64_b32 v[28:29], v226 offset0:64 offset1:66
    ds_read2st64_b32 v[30:31], v226 offset0:80 offset1:82
    ds_read2st64_b32 v[32:33], v226 offset0:96 offset1:98
    ds_read2st64_b32 v[34:35], v226 offset0:112 offset1:114
    s_waitcnt lgkmcnt(6)
    v_pk_add_f32 v[20:21], v[20:21], v[22:23]
    s_waitcnt lgkmcnt(5)
    s_waitcnt lgkmcnt(4)
    v_pk_add_f32 v[24:25], v[24:25], v[26:27]
    s_waitcnt lgkmcnt(3)
    v_pk_add_f32 v[20:21], v[20:21], v[28:29]
    s_waitcnt lgkmcnt(2)
    v_pk_add_f32 v[24:25], v[24:25], v[30:31]
    s_waitcnt lgkmcnt(1)
    v_pk_add_f32 v[20:21], v[20:21], v[32:33]
    s_waitcnt lgkmcnt(0)
    v_pk_add_f32 v[24:25], v[24:25], v[34:35]
    v_pk_add_f32 v[232:233], v[20:21], v[24:25]
    s_barrier
    s_mov_b32 s75, 163840
    s_mov_b32 s79, 0
Lpoll_111:
    buffer_load_dwordx4 v[20:23], v7, s[44:47], s6 offen sc1
    buffer_load_dwordx4 v[24:27], v7, s[44:47], s7 offen sc1
    buffer_load_dwordx4 v[28:31], v7, s[44:47], s8 offen sc1
    buffer_load_dwordx4 v[32:35], v7, s[44:47], s9 offen sc1
    s_cmp_lg_u32 s3, 3
    s_cbranch_scc1 Lw3_113
    buffer_load_dwordx4 v[36:39], v7, s[44:47], s75 offen offset:0 sc1
    buffer_load_dwordx4 v[40:43], v7, s[44:47], s75 offen offset:1024 sc1
    buffer_load_dwordx4 v[44:47], v7, s[44:47], s75 offen offset:2048 sc1
    buffer_load_dwordx4 v[48:51], v7, s[44:47], s75 offen offset:3072 sc1
Lw3_113:
    s_waitcnt vmcnt(0)
    v_lshlrev_b32 v52, 16, v20
    v_and_b32 v53, 0xffff0000, v20
    v_lshlrev_b32 v54, 16, v21
    v_and_b32 v55, 0xffff0000, v21
    v_lshlrev_b32 v56, 16, v22
    v_and_b32 v57, 0xffff0000, v22
    v_lshlrev_b32 v58, 16, v23
    v_and_b32 v59, 0xffff0000, v23
    v_lshlrev_b32 v60, 16, v24
    v_and_b32 v61, 0xffff0000, v24
    v_lshlrev_b32 v62, 16, v25
    v_and_b32 v63, 0xffff0000, v25
    v_lshlrev_b32 v64, 16, v26
    v_and_b32 v65, 0xffff0000, v26
    v_lshlrev_b32 v66, 16, v27
    v_and_b32 v67, 0xffff0000, v27
    v_lshlrev_b32 v68, 16, v28
    v_and_b32 v69, 0xffff0000, v28
    v_lshlrev_b32 v70, 16, v29
    v_and_b32 v71, 0xffff0000, v29
    v_lshlrev_b32 v72, 16, v30
    v_and_b32 v73, 0xffff0000, v30
    v_lshlrev_b32 v74, 16, v31
    v_and_b32 v75, 0xffff0000, v31
    v_lshlrev_b32 v76, 16, v32
    v_and_b32 v77, 0xffff0000, v32
    v_lshlrev_b32 v78, 16, v33
    v_and_b32 v79, 0xffff0000, v33
    v_lshlrev_b32 v80, 16, v34
    v_and_b32 v81, 0xffff0000, v34
    v_lshlrev_b32 v82, 16, v35
    v_and_b32 v83, 0xffff0000, v35
    v_add_f32 v52, v52, v60
    v_add_f32 v68, v68, v76
    v_add_f32 v53, v53, v61
    v_add_f32 v69, v69, v77
    v_add_f32 v54, v54, v62
    v_add_f32 v70, v70, v78
    v_add_f32 v55, v55, v63
    v_add_f32 v71, v71, v79
    v_add_f32 v56, v56, v64
    v_add_f32 v72, v72, v80
    v_add_f32 v57, v57, v65
    v_add_f32 v73, v73, v81
    v_add_f32 v58, v58, v66
    v_add_f32 v74, v74, v82
    v_add_f32 v59, v59, v67
    v_add_f32 v75, v75, v83
    v_add_f32 v168, v52, v68
    v_add_f32 v169, v53, v69
    v_add_f32 v170, v54, v70
    v_add_f32 v171, v55, v71
    v_add_f32 v172, v56, v72
    v_add_f32 v173, v57, v73
    v_add_f32 v174, v58, v74
    v_add_f32 v175, v59, v75
    s_cmp_lg_u32 s3, 3
    s_cbranch_scc1 Lw3_115
    v_lshlrev_b32 v52, 16, v36
    v_and_b32 v53, 0xffff0000, v36
    v_lshlrev_b32 v54, 16, v37
    v_and_b32 v55, 0xffff0000, v37
    v_lshlrev_b32 v56, 16, v38
    v_and_b32 v57, 0xffff0000, v38
    v_lshlrev_b32 v58, 16, v39
    v_and_b32 v59, 0xffff0000, v39
    v_lshlrev_b32 v60, 16, v40
    v_and_b32 v61, 0xffff0000, v40
    v_lshlrev_b32 v62, 16, v41
    v_and_b32 v63, 0xffff0000, v41
    v_lshlrev_b32 v64, 16, v42
    v_and_b32 v65, 0xffff0000, v42
    v_lshlrev_b32 v66, 16, v43
    v_and_b32 v67, 0xffff0000, v43
    v_lshlrev_b32 v68, 16, v44
    v_and_b32 v69, 0xffff0000, v44
    v_lshlrev_b32 v70, 16, v45
    v_and_b32 v71, 0xffff0000, v45
    v_lshlrev_b32 v72, 16, v46
    v_and_b32 v73, 0xffff0000, v46
    v_lshlrev_b32 v74, 16, v47
    v_and_b32 v75, 0xffff0000, v47
    v_lshlrev_b32 v76, 16, v48
    v_and_b32 v77, 0xffff0000, v48
    v_lshlrev_b32 v78, 16, v49
    v_and_b32 v79, 0xffff0000, v49
    v_lshlrev_b32 v80, 16, v50
    v_and_b32 v81, 0xffff0000, v50
    v_lshlrev_b32 v82, 16, v51
    v_and_b32 v83, 0xffff0000, v51
    v_add_f32 v52, v52, v60
    v_add_f32 v68, v68, v76
    v_add_f32 v53, v53, v61
    v_add_f32 v69, v69, v77
    v_add_f32 v54, v54, v62
    v_add_f32 v70, v70, v78
    v_add_f32 v55, v55, v63
    v_add_f32 v71, v71, v79
    v_add_f32 v56, v56, v64
    v_add_f32 v72, v72, v80
    v_add_f32 v57, v57, v65
    v_add_f32 v73, v73, v81
    v_add_f32 v58, v58, v66
    v_add_f32 v74, v74, v82
    v_add_f32 v59, v59, v67
    v_add_f32 v75, v75, v83
    v_add_f32 v204, v52, v68
    v_add_f32 v205, v53, v69
    v_add_f32 v206, v54, v70
    v_add_f32 v207, v55, v71
    v_add_f32 v208, v56, v72
    v_add_f32 v209, v57, v73
    v_add_f32 v210, v58, v74
    v_add_f32 v211, v59, v75
    v_add_f32 v168, v168, v204
    v_add_f32 v169, v169, v205
    v_add_f32 v170, v170, v206
    v_add_f32 v171, v171, v207
    v_add_f32 v172, v172, v208
    v_add_f32 v173, v173, v209
    v_add_f32 v174, v174, v210
    v_add_f32 v175, v175, v211
Lw3_115:
    v_add_f32 v204, v168, v170
    v_add_f32 v206, v172, v174
    v_cmp_u_f32 vcc, v204, v206
    v_fma_f32 v168, v168, v188, v196
    v_fma_f32 v169, v169, v189, v197
    v_fma_f32 v170, v170, v190, v198
    v_fma_f32 v171, v171, v191, v199
    v_fma_f32 v172, v172, v192, v200
    v_fma_f32 v173, v173, v193, v201
    v_fma_f32 v174, v174, v194, v202
    v_fma_f32 v175, v175, v195, v203
    s_cbranch_vccz Lfin_114
    v_max3_u32 v10, v20, v21, v22
    v_max3_u32 v10, v10, v23, v24
    v_max3_u32 v10, v10, v25, v26
    v_max_u32 v10, v10, v27
    v_max3_u32 v11, v28, v29, v30
    v_max3_u32 v11, v11, v31, v32
    v_max3_u32 v11, v11, v33, v34
    v_max_u32 v11, v11, v35
    v_max_u32 v10, v10, v11
    v_cmp_eq_u32 vcc, -1, v10
    s_cbranch_vccnz Lfin_114
    s_cmp_lg_u32 s3, 3
    s_cbranch_scc1 Lfin_114
    v_max3_u32 v10, v36, v37, v38
    v_max3_u32 v10, v10, v39, v40
    v_max3_u32 v10, v10, v41, v42
    v_max_u32 v10, v10, v43
    v_max3_u32 v11, v44, v45, v46
    v_max3_u32 v11, v11, v47, v48
    v_max3_u32 v11, v11, v49, v50
    v_max_u32 v11, v11, v51
    v_max_u32 v10, v10, v11
    v_cmp_eq_u32 vcc, -1, v10
Lfin_114:
    s_cbranch_vccz Ldone_112
    s_sleep 4
    s_add_u32 s79, s79, 1
    s_cmp_lt_u32 s79, 400000
    s_cbranch_scc1 Lpoll_111
Ldone_112:
    v_mul_f32 v20, v168, v176
    v_mul_f32 v21, v169, v177
    v_mul_f32 v22, v170, v178
    v_mul_f32 v23, v171, v179
    v_mul_f32 v24, v172, v180
    v_mul_f32 v25, v173, v181
    v_mul_f32 v26, v174, v182
    v_mul_f32 v27, v175, v183
    v_cvt_pk_bf16_f32 v148, v20, v21
    v_cvt_pk_bf16_f32 v149, v22, v23
    v_cvt_pk_bf16_f32 v150, v24, v25
    v_cvt_pk_bf16_f32 v151, v26, v27
    s_mov_b32 exec_lo, 0xff00ff
    s_mov_b32 exec_hi, 0xff00ff
    v_mov_b32 v152, v148
    v_mov_b32 v153, v149
    v_mov_b32 v154, v150
    v_mov_b32 v155, v151
    s_mov_b32 exec_lo, 0xff00ff00
    s_mov_b32 exec_hi, 0xff00ff00
    v_mov_b32 v164, v148
    v_mov_b32 v165, v149
    v_mov_b32 v166, v150
    v_mov_b32 v167, v151
    s_mov_b64 exec, -1
    v_mfma_f32_16x16x32_bf16 v[204:207], v[152:155], v[84:87], 0
    v_mfma_f32_16x16x32_bf16 v[208:211], v[152:155], v[88:91], 0
    v_mfma_f32_16x16x32_bf16 v[212:215], v[152:155], v[92:95], 0
    v_mfma_f32_16x16x32_bf16 v[216:219], v[152:155], v[96:99], 0
    v_mov_b32_dpp v156, v148 row_ror:8 row_mask:0xf bank_mask:0x3
    v_mov_b32_dpp v157, v149 row_ror:8 row_mask:0xf bank_mask:0x3
    v_mov_b32_dpp v158, v150 row_ror:8 row_mask:0xf bank_mask:0x3
    v_mov_b32_dpp v159, v151 row_ror:8 row_mask:0xf bank_mask:0x3
    v_mov_b32_dpp v160, v148 row_ror:8 row_mask:0xf bank_mask:0xc
    v_mov_b32_dpp v161, v149 row_ror:8 row_mask:0xf bank_mask:0xc
    v_mov_b32_dpp v162, v150 row_ror:8 row_mask:0xf bank_mask:0xc
    v_mov_b32_dpp v163, v151 row_ror:8 row_mask:0xf bank_mask:0xc
    v_mfma_f32_16x16x32_bf16 v[204:207], v[164:167], v[132:135], v[204:207]
    v_mfma_f32_16x16x32_bf16 v[208:211], v[164:167], v[136:139], v[208:211]
    v_mfma_f32_16x16x32_bf16 v[212:215], v[164:167], v[140:143], v[212:215]
    v_mfma_f32_16x16x32_bf16 v[216:219], v[164:167], v[144:147], v[216:219]
    v_add_f32 v234, v168, v169
    v_mul_f32 v235, v168, v168
    v_add_f32 v52, v170, v171
    v_mul_f32 v53, v169, v169
    v_fmac_f32 v235, v170, v170
    v_fmac_f32 v53, v171, v171
    v_fmac_f32 v235, v172, v172
    v_fmac_f32 v53, v173, v173
    v_fmac_f32 v235, v174, v174
    v_fmac_f32 v53, v175, v175
    v_add_f32 v234, v234, v172
    v_add_f32 v52, v52, v173
    v_add_f32 v234, v234, v174
    v_add_f32 v52, v52, v175
    v_add_f32 v234, v234, v52
    v_add_f32 v235, v235, v53
    v_mfma_f32_16x16x32_bf16 v[204:207], v[156:159], v[100:103], v[204:207]
    v_mfma_f32_16x16x32_bf16 v[208:211], v[156:159], v[104:107], v[208:211]
    v_mfma_f32_16x16x32_bf16 v[212:215], v[156:159], v[108:111], v[212:215]
    v_mfma_f32_16x16x32_bf16 v[216:219], v[156:159], v[112:115], v[216:219]
    v_add_f32_dpp v234, v234, v234 row_ror:8 row_mask:0xf bank_mask:0xf
    v_add_f32_dpp v235, v235, v235 row_ror:8 row_mask:0xf bank_mask:0xf
    v_mov_b32 v52, v234
    v_mov_b32 v53, v235
    s_nop 0
    v_permlane16_swap_b32 v234, v52
    v_permlane16_swap_b32 v235, v53
    v_add_f32 v234, v234, v52
    v_add_f32 v235, v235, v53
    v_mfma_f32_16x16x32_bf16 v[204:207], v[160:163], v[116:119], v[204:207]
    v_mfma_f32_16x16x32_bf16 v[208:211], v[160:163], v[120:123], v[208:211]
    v_mfma_f32_16x16x32_bf16 v[212:215], v[160:163], v[124:127], v[212:215]
    v_mfma_f32_16x16x32_bf16 v[216:219], v[160:163], v[128:131], v[216:219]
    v_mov_b32 v52, v234
    v_mov_b32 v53, v235
    s_nop 0
    v_permlane32_swap_b32 v234, v52
    v_permlane32_swap_b32 v235, v53
    v_add_f32 v234, v234, v52
    v_add_f32 v235, v235, v53
    s_mov_b64 exec, 0xff
    ds_write_b64 v8, v[234:235]
    s_mov_b64 exec, -1
    ds_write_b128 v222, v[204:207]
    ds_write_b128 v223, v[208:211]
    ds_write_b128 v224, v[212:215]
    ds_write_b128 v225, v[216:219]
    s_waitcnt lgkmcnt(0)
    s_barrier
    ds_read_b128 v[52:55], v9 offset:0
    ds_read_b128 v[56:59], v9 offset:16
    ds_read_b128 v[60:63], v9 offset:32
    ds_read_b128 v[64:67], v9 offset:48
    ds_read2st64_b32 v[20:21], v226 offset0:0 offset1:2
    ds_read2st64_b32 v[22:23], v226 offset0:16 offset1:18
    ds_read2st64_b32 v[24:25], v226 offset0:32 offset1:34
    ds_read2st64_b32 v[26:27], v226 offset0:48 offset1:50
    ds_read2st64_b32 v[28:29], v226 offset0:64 offset1:66
    ds_read2st64_b32 v[30:31], v226 offset0:80 offset1:82
    ds_read2st64_b32 v[32:33], v226 offset0:96 offset1:98
    ds_read2st64_b32 v[34:35], v226 offset0:112 offset1:114
    s_waitcnt lgkmcnt(10)
    v_pk_add_f32 v[52:53], v[52:53], v[54:55]
    v_pk_add_f32 v[56:57], v[56:57], v[58:59]
    s_waitcnt lgkmcnt(8)
    v_pk_add_f32 v[60:61], v[60:61], v[62:63]
    v_pk_add_f32 v[64:65], v[64:65], v[66:67]
    v_pk_add_f32 v[52:53], v[52:53], v[56:57]
    v_pk_add_f32 v[60:61], v[60:61], v[64:65]
    v_pk_add_f32 v[52:53], v[52:53], v[60:61]
    v_mul_f32 v52, 0x3b000000, v52
    v_mul_f32 v53, 0x3b000000, v53
    v_fma_f32 v53, -v52, v52, v53
    v_max_f32 v53, 0, v53
    v_add_f32 v53, 0x3727c5ac, v53
    v_rsq_f32 v53, v53
    s_waitcnt lgkmcnt(6)
    v_pk_add_f32 v[20:21], v[20:21], v[22:23]
    s_waitcnt lgkmcnt(5)
    s_waitcnt lgkmcnt(4)
    v_pk_add_f32 v[24:25], v[24:25], v[26:27]
    s_waitcnt lgkmcnt(3)
    v_pk_add_f32 v[20:21], v[20:21], v[28:29]
    s_waitcnt lgkmcnt(2)
    v_pk_add_f32 v[24:25], v[24:25], v[30:31]
    s_waitcnt lgkmcnt(1)
    v_pk_add_f32 v[20:21], v[20:21], v[32:33]
    s_waitcnt lgkmcnt(0)
    v_pk_add_f32 v[24:25], v[24:25], v[34:35]
    v_pk_add_f32 v[20:21], v[20:21], v[24:25]
    v_fma_f32 v20, -v52, v230, v20
    v_fma_f32 v21, -v52, v231, v21
    v_fma_f32 v20, v20, v53, v232
    v_fma_f32 v21, v21, v53, v233
    v_mul_f32 v11, 0xbfb8aa3b, v20
    v_exp_f32 v11, v11
    v_mul_f32 v20, v20, v21
    v_add_f32 v11, 1.0, v11
    v_rcp_f32 v11, v11
    s_nop 0
    v_mul_f32 v20, v20, v11
    s_nop 1
    v_mov_b32_dpp v21, v20 row_ror:8 row_mask:0xf bank_mask:0xf
    v_cvt_pk_bf16_f32 v20, v20, v21
    s_mov_b32 exec_lo, 0xff00ff
    s_mov_b32 exec_hi, 0xff00ff
    v_min_u32 v20, -2, v20
    buffer_store_dword v20, v227, s[44:47], s69 offen sc1
    s_endpgm
L_end:
    s_endpgm
.section .rodata,"a"
.p2align 6
.amdhsa_kernel adaLN_cond__sliding_block_cached__swiglu_ffn__decode_kernel
  .amdhsa_next_free_vgpr 256
  .amdhsa_next_free_sgpr 102
  .amdhsa_accum_offset 256
  .amdhsa_group_segment_fixed_size 0
  .amdhsa_kernarg_size 112
  .amdhsa_user_sgpr_count 2
  .amdhsa_user_sgpr_kernarg_segment_ptr 1
  .amdhsa_system_sgpr_workgroup_id_x 1
  .amdhsa_float_denorm_mode_32 3
.end_amdhsa_kernel
```
